```python
import torch

def _softmax(x, axis=-1):
    return torch.softmax(x, dim=axis)
def _gelu(x):
    return torch.nn.functional.gelu(x, approximate="tanh")
def _silu(x):
    return torch.nn.functional.silu(x)
def _sigmoid(x):
    return torch.sigmoid(x)
def _layernorm(x, axis=-1, eps=1e-5):
    m = x.mean(dim=axis, keepdim=True)
    v = x.var(dim=axis, keepdim=True, unbiased=False)
    return (x - m) / torch.sqrt(v + eps)
def _scatter_add(tgt, idx, src, axis=0):
    return tgt.clone().index_add_(axis, idx, src)
def _segment_sum(src, seg, n):
    out = torch.zeros((n,) + src.shape[1:], dtype=src.dtype)
    return out.index_add_(0, seg, src)
def _pad(x, pw):
    flat = tuple(v for pair in reversed(pw) for v in pair)
    return torch.nn.functional.pad(x, flat)

kernel_name = 'parallel_sum__ssm_conv_s5__mixer_channel_mlp__prompt'

def setup_inputs():

    _w = (lambda a: (lambda t: t.to(torch.bfloat16) if t.is_floating_point() else t)(torch.as_tensor(a)))
    def _A_setup():
        B, S, D = 1, 2048, 512
        P = D
        Lambda_re = -0.5 * (lambda _x: torch.exp(torch.as_tensor(_x)))((lambda *s: torch.randn(*s, dtype=torch.bfloat16) * 0.2)(P))
        Lambda_im = (lambda *s: torch.randn(*s, dtype=torch.bfloat16) * 0.8)(P) * 1.0
        B_re = (lambda *s: torch.randn(*s, dtype=torch.bfloat16) * 0.2)(P, D) * (D ** -0.5)
        B_im = (lambda *s: torch.randn(*s, dtype=torch.bfloat16) * 0.2)(P, D) * (D ** -0.5)
        C_re = (lambda *s: torch.randn(*s, dtype=torch.bfloat16) * 0.2)(D, P) * (P ** -0.5)
        C_im = (lambda *s: torch.randn(*s, dtype=torch.bfloat16) * 0.2)(D, P) * (P ** -0.5)
        log_dt = (lambda *s: torch.randn(*s, dtype=torch.bfloat16) * 0.2)(P) * 0.3 - 2.0
        Dskip = (lambda *s: torch.randn(*s, dtype=torch.bfloat16) * 0.05)(D)
        return {
            "x": _w((lambda *s: torch.randn(*s, dtype=torch.bfloat16) * 0.05)(B, S, D)),
            "Lambda_re": _w(Lambda_re),
            "Lambda_im": _w(Lambda_im),
            "B_re": _w(B_re),
            "B_im": _w(B_im),
            "C_re": _w(C_re),
            "C_im": _w(C_im),
            "log_dt": _w(log_dt),
            "Dskip": _w(Dskip),
        }
    _A_in = _A_setup()

    def _B_setup():
        B, S, D, F = 1, 2048, 512, 1376
        return {
            "x": _w((lambda *s: torch.randn(*s, dtype=torch.bfloat16) * 0.05)(B, S, D)),
            "w1": _w((lambda *s: torch.randn(*s, dtype=torch.bfloat16) * 1.6)(D, F) * (D ** -0.5)),
            "b1": _w((lambda *s: torch.randn(*s, dtype=torch.bfloat16) * 0.8)(F)),
            "w2": _w((lambda *s: torch.randn(*s, dtype=torch.bfloat16) * 0.05)(F, D) * (F ** -0.5)),
            "b2": _w((lambda *s: torch.randn(*s, dtype=torch.bfloat16) * 0.05)(D)),
        }
    _B_in = _B_setup()

    return {
        "A_x": _A_in["x"],
        "A_Lambda_re": _A_in["Lambda_re"],
        "A_Lambda_im": _A_in["Lambda_im"],
        "A_B_re": _A_in["B_re"],
        "A_B_im": _A_in["B_im"],
        "A_C_re": _A_in["C_re"],
        "A_C_im": _A_in["C_im"],
        "A_log_dt": _A_in["log_dt"],
        "A_Dskip": _A_in["Dskip"],
        "B_x": _B_in["x"],
        "B_w1": _B_in["w1"],
        "B_b1": _B_in["b1"],
        "B_w2": _B_in["w2"],
        "B_b2": _B_in["b2"],
    }

def reference(A_x, A_Lambda_re, A_Lambda_im, A_B_re, A_B_im, A_C_re, A_C_im, A_log_dt, A_Dskip, B_x, B_w1, B_b1, B_w2, B_b2):
    def _A_ref(x, Lambda_re, Lambda_im, B_re, B_im, C_re, C_im, log_dt, Dskip):
        Bsz, L, H = x.shape
        Lam = Lambda_re + 1j * Lambda_im
        Bmat = B_re + 1j * B_im
        Cmat = C_re + 1j * C_im
        dt = torch.exp(log_dt)
        Lam_bar = torch.exp(dt * Lam)
        B_bar = ((Lam_bar - 1.0) / Lam)[:, None] * Bmat
        Bu = torch.einsum("bld,pd->blp", x + 0j, B_bar)
        h = torch.zeros_like(Bu[:, 0, :])
        hs = []
        for t in range(L):
            h = Lam_bar[None, :] * h + Bu[:, t, :]
            hs.append(h)
        hseq = torch.stack(hs, 1)
        y = 2.0 * torch.einsum("blp,dp->bld", hseq, Cmat).real + x * Dskip[None, None, :]
        return y

    def _B_ref(x, w1, b1, w2, b2):
        y = _layernorm(x, axis=-1)
        h = _gelu(torch.einsum("bsd,df->bsf", y, w1) + b1)
        return torch.einsum("bsf,fd->bsd", h, w2) + b2

    x = A_x
    xn = _layernorm(x, axis=-1)
    return x + _A_ref(xn, A_Lambda_re, A_Lambda_im, A_B_re, A_B_im, A_C_re, A_C_im, A_log_dt, A_Dskip) + _B_ref(xn, B_w1, B_b1, B_w2, B_b2)
```

```asm
; @launch grid=(256,1,1) block=(256,1,1) lds=163840
.amdgcn_target "amdgcn-amd-amdhsa--gfx950"
.text
.globl parallel_sum__ssm_conv_s5__mixer_channel_mlp__prompt_kernel
.p2align 8
.type parallel_sum__ssm_conv_s5__mixer_channel_mlp__prompt_kernel,@function
parallel_sum__ssm_conv_s5__mixer_channel_mlp__prompt_kernel:
    s_cmp_ge_u32 s2, 256
    s_cbranch_scc1 L_end
    s_load_dwordx16 s[64:79], s[0:1], 0
    s_load_dwordx16 s[80:95], s[0:1], 64
    s_load_dwordx2 s[96:97], s[0:1], 128
    s_getpc_b64 s[6:7]
    s_lshr_b32 s47, s2, 3
    v_lshrrev_b32 v2, 5, v0
    v_lshl_add_u32 v2, s47, 3, v2
    v_lshlrev_b32 v2, 7, v2
    v_min_u32 v3, L_fast_end-parallel_sum__ssm_conv_s5__mixer_channel_mlp__prompt_kernel-64, v2
    global_load_dword v47, v3, s[6:7]
    v_lshrrev_b32 v2, 6, v0
    v_and_b32 v1, 63, v0
    v_readfirstlane_b32 s5, v2
    s_and_b32 s47, s2, 7
    s_lshr_b32 s48, s2, 3
    s_and_b32 s3, s47, 3
    s_lshl_b32 s3, s3, 2
    s_and_b32 s49, s48, 3
    s_add_u32 s3, s3, s49
    s_lshr_b32 s4, s47, 2
    s_lshl_b32 s4, s4, 3
    s_lshr_b32 s49, s48, 2
    s_add_u32 s4, s4, s49
    s_lshr_b32 s43, s4, 2
    s_and_b32 s51, s4, 3
    s_lshl_b32 s40, s3, 17
    s_lshl_b32 s47, s5, 15
    s_add_u32 s40, s40, s47
    s_lshl_b32 s41, s4, 15
    s_and_b32 s47, s5, 1
    s_lshl_b32 s47, s47, 13
    s_add_u32 s41, s41, s47
    s_mul_i32 s47, s4, 3
    s_sub_u32 s56, s47, s43
    s_mul_i32 s42, s5, 44032
    s_lshl_b32 s47, s56, 6
    s_add_u32 s42, s42, s47
    s_lshl_b32 s44, s5, 14
    s_lshl_b32 s45, s5, 11
    s_add_u32 s45, s45, 65536
    s_mul_i32 s46, s5, 3072
    s_add_u32 s46, s46, 106496
    v_lshrrev_b32 v99, 5, v1
    v_lshlrev_b32 v96, 14, v99
    v_bfe_u32 v97, v1, 3, 2
    v_lshl_add_u32 v96, v97, 10, v96
    v_and_b32 v97, 7, v1
    v_lshrrev_b32 v98, 4, v1
    v_xor_b32 v97, v97, v98
    v_lshl_add_u32 v4, v97, 4, v96
    v_xor_b32 v97, 4, v97
    v_lshl_add_u32 v5, v97, 4, v96
    v_add_u32 v5, 3072, v5
    v_add_u32 v6, 6144, v4
    v_add_u32 v7, 6144, v5
    v_and_b32 v96, 31, v1
    v_lshlrev_b32 v26, 4, v96
    v_lshl_add_u32 v112, v99, 10, v26
    v_add_u32 v96, 0, v1
    v_mul_u32_u24 v97, 171, v96
    v_lshrrev_b32 v97, 11, v97
    v_mul_u32_u24 v98, 2560, v97
    v_lshl_add_u32 v80, v1, 4, v98
    v_add_u32 v96, 64, v1
    v_mul_u32_u24 v97, 171, v96
    v_lshrrev_b32 v97, 11, v97
    v_mul_u32_u24 v98, 2560, v97
    v_lshl_add_u32 v81, v1, 4, v98
    v_add_u32 v96, 128, v1
    v_mul_u32_u24 v97, 171, v96
    v_lshrrev_b32 v97, 11, v97
    v_mul_u32_u24 v98, 2560, v97
    v_lshl_add_u32 v82, v1, 4, v98
    v_lshlrev_b32 v25, 4, v1
    v_bfe_u32 v96, v1, 2, 1
    v_bfe_u32 v97, v1, 3, 2
    v_and_b32 v98, 3, v1
    v_lshl_add_u32 v98, v97, 2, v98
    v_lshl_add_u32 v44, v96, 4, v98
    s_lshl_b32 s47, s4, 6
    v_lshl_add_u32 v113, v44, 1, s47
    s_lshl_b32 s47, s56, 6
    v_lshrrev_b32 v96, 3, v26
    v_add_u32 v96, s47, v96
    v_add_u32 v234, 0, v96
    v_min_u32 v234, 2750, v234
    v_add_u32 v238, 64, v96
    v_min_u32 v238, 2750, v238
    v_add_u32 v242, 128, v96
    v_min_u32 v242, 2750, v242
    s_add_u32 s6, s3, s4
    s_and_b32 s6, s6, 7
    s_lshl_b32 s6, s6, 7
    s_lshl_b32 s49, s3, 4
    s_add_u32 s49, s49, s4
    s_lshl_b32 s49, s49, 2
    s_add_u32 s49, s49, s5
    s_lshl_b32 s49, s49, 11
    s_mov_b32 s48, 11010048
    s_waitcnt lgkmcnt(0)
    s_load_dwordx2 s[52:53], s[96:97], s48
    s_mov_b32 s8, s64
    s_mov_b32 s9, s65
    s_mov_b32 s10, 2097152
    s_mov_b32 s11, 0x20000
    s_mov_b32 s57, s49
    s_mov_b32 s16, s84
    s_mov_b32 s17, s85
    s_mov_b32 s18, 1409024
    s_mov_b32 s19, 0x20000
    s_cmp_lt_u32 s5, 2
    s_cselect_b32 s12, s70, s72
    s_cselect_b32 s13, s71, s73
    s_mov_b32 s14, 524288
    s_mov_b32 s15, 0x20000
    global_load_ushort v244, v113, s[66:67]
    global_load_ushort v245, v113, s[68:69]
    global_load_ushort v246, v113, s[78:79]
    global_load_ushort v234, v234, s[86:87]
    global_load_ushort v238, v238, s[86:87]
    global_load_ushort v242, v242, s[86:87]
    s_lshl_b32 s47, s51, 2
    s_add_u32 s47, s47, s43
    s_lshl_b32 s47, s47, 6
    v_lshl_add_u32 v113, v44, 1, s47
    global_load_ushort a246, v113, s[80:81]
    global_load_ushort a247, v113, s[90:91]
    s_getreg_b32 s79, hwreg(HW_REG_XCC_ID, 0, 4)
    s_mov_b32 s84, s96
    s_mov_b32 s85, s97
    s_lshl_b32 s47, s4, 13
    s_add_u32 s86, s47, 10559488
    s_mov_b32 s87, 0x20000
    buffer_load_dwordx4 v[104:107], v112, s[8:11], s57 offen
    buffer_load_dwordx4 v[108:111], v112, s[8:11], s57 offen offset:512
    s_add_u32 m0, s44, 0
    s_add_u32 s70, s40, s6
    buffer_load_dwordx4 v4, s[8:11], s70 offen offset:0 lds
    buffer_load_dwordx4 v5, s[8:11], s70 offen offset:1024 lds
    buffer_load_dwordx4 v6, s[8:11], s70 offen offset:2048 lds
    buffer_load_dwordx4 v7, s[8:11], s70 offen offset:3072 lds
    s_add_u32 m0, s45, 0
    s_add_u32 s70, s41, s6
    buffer_load_dwordx4 v4, s[12:15], s70 offen offset:0 lds
    buffer_load_dwordx4 v5, s[12:15], s70 offen offset:1024 lds
    s_mul_i32 s7, s6, 1376
    s_add_u32 m0, s46, 0
    s_add_u32 s70, s42, s7
    buffer_load_dwordx4 v80, s[16:19], s70 offen offset:0 lds
    buffer_load_dwordx4 v81, s[16:19], s70 offen offset:1024 lds
    buffer_load_dwordx4 v82, s[16:19], s70 offen offset:2048 lds
    s_mov_b32 s20, s96
    s_mov_b32 s21, s97
    s_mov_b32 s22, 268435456
    s_mov_b32 s23, 0x20000
    v_lshlrev_b32 v96, 3, v26
    v_bfe_u32 v97, v1, 1, 3
    v_lshrrev_b32 v99, 5, v1
    v_xor_b32 v97, v97, v99
    v_lshl_add_u32 v140, v97, 4, v96
    v_bfe_u32 v97, v1, 2, 2
    v_lshl_add_u32 v96, v99, 3, v97
    v_mul_u32_u24 v96, 192, v96
    v_bfe_u32 v97, v1, 4, 1
    v_lshl_add_u32 v96, v97, 5, v96
    v_and_b32 v97, 3, v1
    v_lshl_add_u32 v96, v97, 3, v96
    v_add_u32 v96, 106496, v96
    s_add_u32 s47, s5, 0
    s_and_b32 s47, s47, 3
    s_lshl_b32 s48, s47, 5
    s_mul_i32 s47, s47, 3072
    v_xor_b32 v98, s48, v140
    v_add_u32 v83, s47, v96
    v_add_u32 v52, s44, v98
    v_add_u32 v56, 65536, v98
    s_add_u32 s47, s5, 1
    s_and_b32 s47, s47, 3
    s_lshl_b32 s48, s47, 5
    s_mul_i32 s47, s47, 3072
    v_xor_b32 v98, s48, v140
    v_add_u32 v84, s47, v96
    v_add_u32 v53, s44, v98
    v_add_u32 v57, 65536, v98
    s_add_u32 s47, s5, 2
    s_and_b32 s47, s47, 3
    s_lshl_b32 s48, s47, 5
    s_mul_i32 s47, s47, 3072
    v_xor_b32 v98, s48, v140
    v_add_u32 v85, s47, v96
    v_add_u32 v54, s44, v98
    v_add_u32 v58, 65536, v98
    s_add_u32 s47, s5, 3
    s_and_b32 s47, s47, 3
    s_lshl_b32 s48, s47, 5
    s_mul_i32 s47, s47, 3072
    v_xor_b32 v98, s48, v140
    v_add_u32 v86, s47, v96
    v_add_u32 v55, s44, v98
    v_add_u32 v59, 65536, v98
    v_lshrrev_b32 v96, 2, v1
    v_lshrrev_b32 v98, 4, v1
    v_xor_b32 v96, v96, v98
    v_and_b32 v96, 1, v96
    v_cmp_eq_u32 vcc, 0, v96
    v_mov_b32 v97, 0x3f803f80
    s_lshl_b32 s47, s5, 1
    v_add_u32 v45, s47, v99
    v_cndmask_b32 v28, 0, v97, vcc
    v_cndmask_b32 v29, 0, v97, vcc
    v_cndmask_b32 v30, 0, v97, vcc
    v_cndmask_b32 v31, 0, v97, vcc
    v_cmp_eq_u32 vcc, 0, v1
    v_mov_b32 v97, 2146435072
    s_lshl_b32 s65, s51, 8
    s_lshl_b32 s47, s43, 6
    v_cndmask_b32 v27, v97, v1, vcc
    s_add_u32 s65, s65, s47
    s_sub_u32 s65, s65, s6
    s_bfe_u32 s65, s65, 0x30007
    s_lshr_b32 s83, s57, 11
    v_lshrrev_b32 v75, 5, v1
    v_bfe_u32 v73, v1, 2, 2
    v_lshl_add_u32 v72, v75, 2, v73
    v_lshlrev_b32 v72, 7, v72
    v_and_b32 v73, 1, v1
    v_lshl_add_u32 v72, v73, 5, v72
    v_bfe_u32 v73, v1, 4, 1
    v_lshl_add_u32 v72, v73, 4, v72
    v_bfe_u32 v73, v1, 1, 1
    v_lshl_add_u32 v72, v73, 3, v72
    v_bfe_u32 v73, v1, 3, 1
    s_and_b32 s47, s43, 1
    v_xor_b32 v73, s47, v73
    v_lshl_add_u32 v74, v73, 6, v72
    v_add_u32 v252, 65536, v74
    v_add_u32 v254, 106496, v74
    v_xor_b32 v74, 64, v74
    v_add_u32 v253, 65536, v74
    v_add_u32 v255, 106496, v74
    v_lshrrev_b32 v73, 4, v72
    v_and_b32 v73, 0x30, v73
    v_xor_b32 v73, v73, v72
    s_lshl_b32 s47, s47, 6
    s_add_u32 s47, s47, s44
    v_add_u32 v64, s47, v73
    v_xor_b32 v65, 64, v64
    s_mov_b32 s32, s88
    s_mov_b32 s33, s89
    s_mov_b32 s34, 1409024
    s_mov_b32 s35, 0x20000
    s_bitcmp1_b32 s3, 1
    s_cselect_b32 s24, s76, s74
    s_cselect_b32 s28, s74, s76
    s_cselect_b32 s25, s77, s75
    s_cselect_b32 s29, s75, s77
    s_mov_b32 s26, 524288
    s_mov_b32 s27, 0x20000
    s_mov_b32 s30, 524288
    s_mov_b32 s31, 0x20000
    v_xor_b32 v141, 32, v140
    v_xor_b32 v142, 64, v140
    v_xor_b32 v143, 96, v140
    v_lshrrev_b32 v72, 3, v1
    v_lshlrev_b32 v72, 10, v72
    v_bfe_u32 v73, v1, 4, 1
    v_lshlrev_b32 v73, 2, v73
    v_and_b32 v74, 7, v1
    v_xor_b32 v73, v73, v74
    v_lshl_add_u32 v136, v73, 4, v72
    v_add_u32 v137, 15360, v136
    v_add_u32 v138, 30720, v136
    s_xor_b32 s47, s5, s43
    s_lshl_b32 s48, s51, 2
    s_add_u32 s48, s48, s47
    s_lshl_b32 s48, s48, 15
    s_lshr_b32 s49, s4, 1
    s_and_b32 s50, s3, 1
    s_xor_b32 s49, s49, s50
    s_lshl_b32 s49, s49, 7
    s_add_u32 s72, s48, s49
    s_xor_b32 s73, s72, 128
    s_lshr_b32 s47, s47, 1
    s_lshl_b32 s47, s47, 7
    s_lshl_b32 s48, s51, 8
    s_add_u32 s47, s47, s48
    s_mul_i32 s71, s43, 360448
    s_add_u32 s71, s71, s47
    s_and_b32 s47, s5, 1
    s_lshl_b32 s47, s47, 13
    s_add_u32 s71, s71, s47
    s_lshl_b32 s47, s3, 2
    s_add_u32 s47, s47, s5
    s_lshl_b32 s47, s47, 2
    s_add_u32 s47, s47, s43
    s_mul_i32 s77, s47, 40960
    s_lshl_b32 s50, s51, 11
    s_add_u32 s64, s77, s50
    s_lshl_b32 s74, s47, 9
    s_add_u32 s74, s74, 11534336
    s_lshl_b32 s47, s5, 2
    s_add_u32 s47, s47, 155648
    v_add_u32 v139, s47, v26
    v_mov_b32 v224, 0
    v_mov_b32 v225, 0
    v_mov_b32 v226, 0
    v_mov_b32 v228, 0
    v_mov_b32 v229, 0
    v_mov_b32 v230, 0
    v_mov_b32 v235, 0
    v_mov_b32 v239, 0
    v_mov_b32 v243, 0
    v_lshlrev_b32 v72, 3, v0
    v_add_u32 v72, 159232, v72
    ds_write_b64 v72, v[224:225]
    s_add_u32 s95, s71, 49152
    s_and_b32 s47, s3, 3
    s_lshl_b32 s47, s47, 3
    s_lshr_b32 s47, 0x9372b1e4, s47
    s_bfe_u32 s48, s47, 0x20000
    s_xor_b32 s48, s48, s51
    s_mul_i32 s48, s48, 98304
    s_add_u32 s60, s48, s71
    s_bfe_u32 s48, s47, 0x20002
    s_xor_b32 s48, s48, s51
    s_mul_i32 s48, s48, 98304
    s_add_u32 s61, s48, s71
    s_bfe_u32 s48, s47, 0x20004
    s_xor_b32 s48, s48, s51
    s_mul_i32 s48, s48, 98304
    s_add_u32 s62, s48, s71
    s_bfe_u32 s48, s47, 0x20006
    s_xor_b32 s48, s48, s51
    s_mul_i32 s48, s48, 98304
    s_add_u32 s63, s48, s71
    s_mov_b32 s36, s92
    s_mov_b32 s37, s93
    s_mov_b32 s38, 4194304
    s_mov_b32 s39, 0x20000
    v_lshrrev_b32 v19, 1, v26
    v_lshl_add_u32 v19, v45, 8, v19
    v_add_u32 v19, 159488, v19
    v_cmp_eq_u32 vcc, 7, v45
    v_mov_b32 v20, 2146435072
    s_lshl_b32 s47, s3, 9
    s_sub_u32 s50, s86, s47
    v_cndmask_b32 v20, v20, v26, vcc
    s_sub_u32 s0, s50, 512
    v_lshrrev_b32 v22, 5, v1
    v_lshl_add_u32 v9, v22, 9, v26
    s_lshl_b32 s48, s5, 11
    s_add_u32 s94, s50, s48
    s_lshl_b32 s48, s5, 2
    s_sub_i32 s48, s3, s48
    s_add_i32 s48, s48, 1
    v_sub_i32 v22, s48, v22
    v_ashrrev_i32 v22, 1, v22
    v_med3_i32 v22, v22, 0, 2
    v_lshrrev_b32 v21, 1, v26
    v_add_u32 v21, 161280, v21
    s_and_b32 s75, s3, 2
    s_xor_b32 s75, s75, 3
    s_lshl_b32 s75, s75, 12
    s_add_u32 s75, s75, s44
    v_lshrrev_b32 v72, 5, v1
    v_lshl_add_u32 v11, v72, 5, s75
    v_bfe_u32 v12, v1, 2, 2
    v_lshl_add_u32 v12, v72, 3, v12
    v_lshl_add_u32 v12, v12, 6, s75
    v_lshl_add_u32 v11, v44, 6, v11
    v_and_b32 v72, 1, v1
    v_lshl_add_u32 v12, v72, 5, v12
    v_bfe_u32 v72, v1, 4, 1
    v_lshl_add_u32 v12, v72, 4, v12
    v_bfe_u32 v72, v1, 1, 1
    v_lshl_add_u32 v12, v72, 3, v12
    v_lshlrev_b32 v72, 3, v1
    v_and_b32 v72, 0x30, v72
    v_xor_b32 v11, v11, v72
    v_lshlrev_b32 v72, 1, v1
    v_and_b32 v72, 0x10, v72
    v_xor_b32 v12, v12, v72
    v_xor_b32 v10, 16, v11
    v_xor_b32 v0, 32, v12
    s_xor_b32 s75, s51, 1
    s_lshl_b32 s75, s75, 11
    v_add_u32 v15, s75, v25
    s_xor_b32 s75, s51, 2
    s_lshl_b32 s75, s75, 11
    v_add_u32 v16, s75, v25
    s_xor_b32 s75, s51, 3
    s_lshl_b32 s75, s75, 11
    v_add_u32 v17, s75, v25
    v_lshl_add_u32 v24, v1, 2, v26
    v_and_b32 v24, 12, v24
    v_and_b32 v23, 0x1c0, v26
    v_or_b32 v24, v24, v23
    s_lshl_b32 s67, s51, 2
    s_add_u32 s67, s67, s74
    s_lshl_b32 s75, s51, 2
    s_add_u32 s75, s75, s43
    s_lshl_b32 s75, s75, 6
    s_add_u32 s1, s40, s75
    s_lshl_b32 s1, s1, 1
    v_lshrrev_b32 v14, 5, v1
    v_lshlrev_b32 v14, 15, v14
    v_lshl_add_u32 v14, v44, 2, v14
    v_lshlrev_b32 v13, 2, v1
    s_mov_b32 s56, 0x3f80
    s_mov_b32 s57, 0x3f800000
    s_mul_i32 s80, s51, 1536
    s_sub_u32 s80, 8192, s80
    s_add_u32 s81, s80, 8192
    s_lshl_b32 s47, s51, 4
    s_add_u32 s47, s47, s3
    s_lshl_b32 s47, s47, 5
    s_add_u32 s47, s47, s43
    s_lshl_b32 s47, s47, 8
    s_lshl_b32 s48, s43, 4
    s_add_u32 s48, s48, s3
    s_lshl1_add_u32 s48, s48, s5
    s_sub_u32 s48, s48, 2
    s_mul_i32 s48, s48, 44
    s_add_u32 s48, s48, s51
    s_lshl_b32 s48, s48, 8
    s_cmp_lt_u32 s5, 2
    s_cselect_b32 s47, s47, s48
    s_cselect_b32 s48, 16, 22
    v_lshrrev_b32 v89, 1, v1
    v_and_b32 v72, 1, v1
    v_lshl_add_u32 v89, v89, 10, s47
    v_lshl_add_u32 v89, v72, 7, v89
    v_cmp_gt_u32 vcc, s48, v1
    v_mov_b32 v72, 2146435072
    s_nop 0
    v_cndmask_b32 v89, v72, v89, vcc
    s_lshl_b32 s47, s51, 9
    s_add_u32 s47, s47, s77
    s_add_u32 s47, s47, 38912
    v_lshl_add_u32 v18, v1, 3, s47
    buffer_store_dwordx2 v[26:27], v18, s[20:23], 0 offen sc1
    s_waitcnt vmcnt(17)
    v_lshlrev_b32 v246, 16, v246
    v_mul_f32 v246, 0x3fb8aa3b, v246
    v_exp_f32 v246, v246
    v_lshlrev_b32 v244, 16, v244
    v_lshlrev_b32 v245, 16, v245
    v_cvt_pk_bf16_f32 v246, v246, v246
    v_lshlrev_b32 v246, 16, v246
    v_mul_f32 v250, v246, v244
    v_mul_f32 v251, v246, v245
    v_mul_f32 v250, 0x3fb8aa3b, v250
    v_mul_f32 v251, 0x3e22f983, v251
    v_mul_f32 v247, 1.0, v250
    v_mul_f32 v248, 1.0, v251
    v_exp_f32 v247, v247
    v_fract_f32 v248, v248
    v_cos_f32 v32, v248
    v_sin_f32 v33, v248
    v_mul_f32 v32, v32, v247
    v_mul_f32 v33, -v33, v247
    v_mul_f32 v247, 0x41800000, v250
    v_mul_f32 v248, 0x41800000, v251
    v_exp_f32 v247, v247
    v_fract_f32 v248, v248
    v_cos_f32 v36, v248
    v_sin_f32 v37, v248
    v_mul_f32 v36, v36, v247
    v_mul_f32 v37, -v37, v247
    s_lshl_b32 s47, s5, 1
    v_add_lshl_u32 v249, v45, s47, 7
    v_cvt_f32_u32 v249, v249
    v_mul_f32 v247, v249, v250
    v_mul_f32 v248, v249, v251
    v_exp_f32 v247, v247
    v_fract_f32 v248, v248
    v_cos_f32 v38, v248
    v_sin_f32 v39, v248
    v_mul_f32 v38, v38, v247
    v_mul_f32 v39, -v39, v247
    v_mul_f32 v247, 0x43800000, v250
    v_mul_f32 v248, 0x43800000, v251
    v_exp_f32 v247, v247
    v_fract_f32 v248, v248
    v_cos_f32 v40, v248
    v_sin_f32 v41, v248
    v_mul_f32 v40, v40, v247
    v_mul_f32 v41, -v41, v247
    v_lshlrev_b32 v249, 4, v45
    v_cvt_f32_u32 v249, v249
    v_mul_f32 v247, v249, v250
    v_mul_f32 v248, v249, v251
    v_exp_f32 v247, v247
    v_fract_f32 v248, v248
    v_cos_f32 v42, v248
    v_sin_f32 v43, v248
    v_mul_f32 v42, v42, v247
    v_mul_f32 v43, -v43, v247
    v_mul_f32 v247, v244, v244
    v_fma_f32 v247, v245, v245, v247
    v_rcp_f32 v247, v247
    v_add_f32 v248, -1.0, v32
    v_add_f32 v247, v247, v247
    v_mul_f32 v34, v248, v244
    v_fma_f32 v34, -v33, v245, v34
    v_mul_f32 v35, -v33, v244
    v_fma_f32 v35, -v248, v245, v35
    v_mul_f32 v34, v34, v247
    v_mul_f32 v35, v35, v247
    s_mov_b32 s47, 0x3f803f80
    s_waitcnt vmcnt(11)
    v_dot2_f32_bf16 v96, v104, s47, 0
    v_dot2_f32_bf16 v97, v104, v104, 0
    v_dot2_f32_bf16 v96, v105, s47, v96
    v_dot2_f32_bf16 v97, v105, v105, v97
    v_dot2_f32_bf16 v96, v106, s47, v96
    v_dot2_f32_bf16 v97, v106, v106, v97
    v_dot2_f32_bf16 v96, v107, s47, v96
    v_dot2_f32_bf16 v97, v107, v107, v97
    s_waitcnt vmcnt(10)
    s_nop 0
    v_dot2_f32_bf16 v96, v108, s47, v96
    v_dot2_f32_bf16 v97, v108, v108, v97
    v_dot2_f32_bf16 v96, v109, s47, v96
    v_dot2_f32_bf16 v97, v109, v109, v97
    v_dot2_f32_bf16 v96, v110, s47, v96
    v_dot2_f32_bf16 v97, v110, v110, v97
    v_dot2_f32_bf16 v96, v111, s47, v96
    v_dot2_f32_bf16 v97, v111, v111, v97
    s_waitcnt lgkmcnt(0)
    s_nop 0
    s_mul_i32 s52, s52, 0x0019660d
    s_add_u32 s52, s52, 0x3c6ef35f
    s_mul_i32 s53, s53, 0x41c64e6d
    v_add_f32_dpp v96, v96, v96 row_ror:8 row_mask:0xf bank_mask:0xf
    v_add_f32_dpp v97, v97, v97 row_ror:8 row_mask:0xf bank_mask:0xf
    s_add_u32 s53, s53, 0x00003039
    v_add_f32_dpp v96, v96, v96 row_ror:4 row_mask:0xf bank_mask:0xf
    v_add_f32_dpp v97, v97, v97 row_ror:4 row_mask:0xf bank_mask:0xf
    s_or_b32 s53, s53, 0x80000000
    v_add_f32_dpp v96, v96, v96 row_ror:2 row_mask:0xf bank_mask:0xf
    v_add_f32_dpp v97, v97, v97 row_ror:2 row_mask:0xf bank_mask:0xf
    s_andn2_b32 s53, s53, 15
    v_add_f32_dpp v96, v96, v96 row_ror:1 row_mask:0xf bank_mask:0xf
    v_add_f32_dpp v97, v97, v97 row_ror:1 row_mask:0xf bank_mask:0xf
    v_mov_b32 v98, v96
    v_mov_b32 v99, v97
    s_or_b32 s79, s79, s53
    v_permlane16_swap_b32 v96, v98
    v_permlane16_swap_b32 v97, v99
    v_add_f32 v96, v96, v98
    v_add_f32 v97, v97, v99
    v_mul_f32 v96, 0x3b000000, v96
    v_mul_f32 v97, 0x3b000000, v97
    v_fma_f32 v97, -v96, v96, v97
    v_max_f32 v97, 0, v97
    v_cvt_pk_bf16_f32 v99, v97, v97
    v_lshlrev_b32 v99, 16, v99
    v_add_f32 v99, 0x3727c5ac, v99
    v_cvt_pk_bf16_f32 v99, v99, v99
    v_lshlrev_b32 v99, 16, v99
    v_sqrt_f32 v99, v99
    v_mov_b32 v106, s52
    v_mov_b32 v8, s52
    v_cvt_pk_bf16_f32 v104, v96, v99
    v_and_b32 v99, 0xffff0000, v104
    v_lshlrev_b32 v98, 16, v104
    v_rcp_f32 v100, v99
    v_sub_f32 v101, v96, v98
    v_mul_f32 v102, v97, v100
    v_mul_f32 v101, v101, v100
    v_mul_f32 v102, v102, v100
    v_cvt_pk_bf16_f32 v102, v102, v102
    v_lshlrev_b32 v102, 16, v102
    v_add_f32 v102, 0x3727c5ac, v102
    v_cvt_pk_bf16_f32 v102, v102, v102
    v_lshlrev_b32 v102, 16, v102
    v_sqrt_f32 v102, v102
    v_mov_b32 v107, s79
    v_cvt_pk_bf16_f32 v105, v101, v102
    v_cmp_eq_u32 vcc, 0, v26
    v_lshrrev_b32 v103, 1, v1
    s_lshl_b32 s47, s83, 5
    s_add_u32 s47, s47, 10747904
    v_cndmask_b32 v103, v27, v103, vcc
    buffer_store_dwordx4 v[104:107], v103, s[20:23], s47 offen sc1
    s_lshr_b32 s66, s40, 6
    s_add_u32 s66, s66, 10747904
    v_lshlrev_b32 v66, 4, v44
    s_andn2_b32 s76, s83, 31
    s_lshl_b32 s76, s76, 5
    s_add_u32 s76, s76, 10747904
    v_and_b32 v67, 7, v1
    v_lshlrev_b32 v67, 7, v67
    s_lshl_b32 s48, s5, 8
    s_add_u32 s48, s48, 158208
    v_lshl_add_u32 v88, v44, 2, s48
    v_lshrrev_b32 v87, 5, v1
    v_lshl_add_u32 v251, v87, 6, s48
    v_lshl_add_u32 v87, v87, 3, v26
    v_add_u32 v87, 155648, v87
    s_mov_b32 s78, s52
    s_add_u32 s6, s6, 128
    s_and_b32 s6, s6, 0x380
    s_add_u32 m0, s44, 4096
    s_add_u32 s70, s40, s6
    buffer_load_dwordx4 v4, s[8:11], s70 offen offset:0 lds
    buffer_load_dwordx4 v5, s[8:11], s70 offen offset:1024 lds
    buffer_load_dwordx4 v6, s[8:11], s70 offen offset:2048 lds
    buffer_load_dwordx4 v7, s[8:11], s70 offen offset:3072 lds
    s_add_u32 m0, s45, 8192
    s_add_u32 s70, s41, s6
    buffer_load_dwordx4 v4, s[12:15], s70 offen offset:0 lds
    buffer_load_dwordx4 v5, s[12:15], s70 offen offset:1024 lds
    s_waitcnt vmcnt(8)
    s_barrier
    s_nop 0
    ds_read_b128 a[0:3], v52 offset:0
    ds_read_b128 a[128:131], v56 offset:0
    ds_read_b128 a[132:135], v56 offset:4096
    ds_read_b64_tr_b16 a[136:137], v83 offset:0
    ds_read_b64_tr_b16 a[138:139], v83 offset:768
    ds_read_b64_tr_b16 a[140:141], v83 offset:64
    ds_read_b64_tr_b16 a[142:143], v83 offset:832
    ds_read_b64_tr_b16 a[144:145], v83 offset:128
    ds_read_b64_tr_b16 a[146:147], v83 offset:896
    s_waitcnt lgkmcnt(7)
    v_mfma_f32_32x32x16_bf16 v[144:159], a[0:3], a[128:131], 0
    ds_read_b128 a[4:7], v53 offset:0
    ds_read_b128 a[148:151], v57 offset:0
    s_add_u32 s6, s6, 128
    s_and_b32 s6, s6, 0x380
    s_add_u32 m0, s44, 8192
    s_add_u32 s70, s40, s6
    v_mfma_f32_16x16x32_bf16 a[192:195], v[28:31], a[128:131], 0
    buffer_load_dwordx4 v4, s[8:11], s70 offen offset:0 lds
    s_waitcnt lgkmcnt(8)
    v_mfma_f32_32x32x16_bf16 v[160:175], a[0:3], a[132:135], 0
    ds_read_b128 a[152:155], v57 offset:4096
    buffer_load_dwordx4 v5, s[8:11], s70 offen offset:1024 lds
    v_mfma_f32_16x16x32_bf16 a[196:199], v[28:31], a[132:135], 0
    buffer_load_dwordx4 v6, s[8:11], s70 offen offset:2048 lds
    s_waitcnt lgkmcnt(5)
    v_mfma_f32_32x32x16_bf16 v[176:191], a[136:139], a[0:3], 0
    ds_read_b64_tr_b16 a[156:157], v84 offset:0
    ds_read_b64_tr_b16 a[158:159], v84 offset:768
    v_mfma_f32_16x16x32_bf16 a[200:203], v[28:31], a[136:139], 0
    buffer_load_dwordx4 v7, s[8:11], s70 offen offset:3072 lds
    v_mfma_f32_32x32x16_bf16 v[192:207], a[140:143], a[0:3], 0
    ds_read_b64_tr_b16 a[128:129], v84 offset:64
    ds_read_b64_tr_b16 a[130:131], v84 offset:832
    s_add_u32 m0, s45, 16384
    s_add_u32 s70, s41, s6
    buffer_load_dwordx4 v4, s[12:15], s70 offen offset:0 lds
    v_mfma_f32_16x16x32_bf16 a[204:207], v[28:31], a[140:143], 0
    buffer_load_dwordx4 v5, s[12:15], s70 offen offset:1024 lds
    s_waitcnt lgkmcnt(5)
    v_mfma_f32_32x32x16_bf16 v[208:223], a[144:147], a[0:3], 0
    ds_read_b64_tr_b16 a[132:133], v84 offset:128
    ds_read_b64_tr_b16 a[134:135], v84 offset:896
    v_mfma_f32_16x16x32_bf16 a[208:211], v[28:31], a[144:147], 0
    s_add_u32 s6, s6, 128
    s_and_b32 s6, s6, 0x380
    s_add_u32 m0, s44, 12288
    s_add_u32 s70, s40, s6
    v_mfma_f32_32x32x16_bf16 v[144:159], a[4:7], a[148:151], v[144:159]
    ds_read_b128 a[8:11], v54 offset:0
    ds_read_b128 a[136:139], v58 offset:0
    buffer_load_dwordx4 v4, s[8:11], s70 offen offset:0 lds
    s_waitcnt lgkmcnt(6)
    v_mfma_f32_32x32x16_bf16 v[160:175], a[4:7], a[152:155], v[160:175]
    ds_read_b128 a[140:143], v58 offset:4096
    buffer_load_dwordx4 v5, s[8:11], s70 offen offset:1024 lds
    s_cmp_eq_u32 s65, 0
    s_cbranch_scc1 L_xc0
L_nx0:
    v_mfma_f32_32x32x16_bf16 v[176:191], a[156:159], a[4:7], v[176:191]
    ds_read_b128 a[12:15], v55 offset:0
    ds_read_b128 a[144:147], v59 offset:0
    buffer_load_dwordx4 v6, s[8:11], s70 offen offset:2048 lds
    s_waitcnt lgkmcnt(5)
    v_mfma_f32_32x32x16_bf16 v[192:207], a[128:131], a[4:7], v[192:207]
    ds_read_b128 a[148:151], v59 offset:4096
    v_mfma_f32_32x32x16_bf16 v[208:223], a[132:135], a[4:7], v[208:223]
    s_waitcnt vmcnt(9)
    s_barrier
    ds_read_b128 a[16:19], v52 offset:4096
    ds_read_b128 a[152:155], v56 offset:8192
    s_waitcnt lgkmcnt(5)
    v_mfma_f32_32x32x16_bf16 v[144:159], a[8:11], a[136:139], v[144:159]
    ds_read_b128 a[156:159], v56 offset:12288
    buffer_load_dwordx4 v7, s[8:11], s70 offen offset:3072 lds
    s_add_u32 m0, s45, 24576
    s_add_u32 s70, s41, s6
    buffer_load_dwordx4 v4, s[12:15], s70 offen offset:0 lds
    v_mfma_f32_32x32x16_bf16 v[160:175], a[8:11], a[140:143], v[160:175]
    ds_read_b128 a[20:23], v53 offset:4096
    ds_read_b128 a[128:131], v57 offset:8192
    buffer_load_dwordx4 v5, s[12:15], s70 offen offset:1024 lds
    s_waitcnt lgkmcnt(5)
    v_mfma_f32_32x32x16_bf16 v[144:159], a[12:15], a[144:147], v[144:159]
    ds_read_b128 a[132:135], v57 offset:12288
    v_mfma_f32_32x32x16_bf16 v[160:175], a[12:15], a[148:151], v[160:175]
    ds_read_b128 a[24:27], v54 offset:4096
    ds_read_b128 a[136:139], v58 offset:8192
    s_add_u32 s6, s6, 128
    s_and_b32 s6, s6, 0x380
    s_add_u32 m0, s44, 0
    s_add_u32 s70, s40, s6
    s_waitcnt lgkmcnt(5)
    v_mfma_f32_32x32x16_bf16 v[144:159], a[16:19], a[152:155], v[144:159]
    ds_read_b128 a[140:143], v58 offset:12288
    buffer_load_dwordx4 v4, s[8:11], s70 offen offset:0 lds
    v_mfma_f32_16x16x32_bf16 a[192:195], v[28:31], a[152:155], a[192:195]
    v_mfma_f32_32x32x16_bf16 v[160:175], a[16:19], a[156:159], v[160:175]
    ds_read_b128 a[28:31], v55 offset:4096
    ds_read_b128 a[144:147], v59 offset:8192
    buffer_load_dwordx4 v5, s[8:11], s70 offen offset:1024 lds
    v_mfma_f32_16x16x32_bf16 a[196:199], v[28:31], a[156:159], a[196:199]
    s_cmp_eq_u32 s65, 1
    s_cbranch_scc1 L_xc1
L_nx1:
    s_waitcnt lgkmcnt(5)
    v_mfma_f32_32x32x16_bf16 v[144:159], a[20:23], a[128:131], v[144:159]
    ds_read_b128 a[148:151], v59 offset:12288
    buffer_load_dwordx4 v6, s[8:11], s70 offen offset:2048 lds
    v_mfma_f32_32x32x16_bf16 v[160:175], a[20:23], a[132:135], v[160:175]
    s_waitcnt vmcnt(9)
    s_barrier
    ds_read_b128 a[32:35], v52 offset:8192
    ds_read_b128 a[152:155], v56 offset:16384
    s_waitcnt lgkmcnt(5)
    v_mfma_f32_32x32x16_bf16 v[144:159], a[24:27], a[136:139], v[144:159]
    ds_read_b128 a[156:159], v56 offset:20480
    buffer_load_dwordx4 v7, s[8:11], s70 offen offset:3072 lds
    v_mfma_f32_32x32x16_bf16 v[160:175], a[24:27], a[140:143], v[160:175]
    ds_read_b128 a[36:39], v53 offset:8192
    ds_read_b128 a[128:131], v57 offset:16384
    s_add_u32 m0, s45, 0
    s_add_u32 s70, s41, s6
    buffer_load_dwordx4 v4, s[12:15], s70 offen offset:0 lds
    s_waitcnt lgkmcnt(5)
    v_mfma_f32_32x32x16_bf16 v[144:159], a[28:31], a[144:147], v[144:159]
    ds_read_b128 a[132:135], v57 offset:20480
    v_mfma_f32_32x32x16_bf16 v[160:175], a[28:31], a[148:151], v[160:175]
    ds_read_b128 a[40:43], v54 offset:8192
    ds_read_b128 a[136:139], v58 offset:16384
    buffer_load_dwordx4 v5, s[12:15], s70 offen offset:1024 lds
    s_waitcnt lgkmcnt(5)
    v_mfma_f32_32x32x16_bf16 v[144:159], a[32:35], a[152:155], v[144:159]
    ds_read_b128 a[140:143], v58 offset:20480
    v_cmp_gt_u32 vcc, 32, v1
    v_lshl_or_b32 v234, v234, 16, v234
    v_lshl_or_b32 v238, v238, 16, v238
    v_lshl_or_b32 v242, v242, 16, v242
    v_cndmask_b32 v234, 0, v234, vcc
    v_cndmask_b32 v238, 0, v238, vcc
    v_cndmask_b32 v242, 0, v242, vcc
    v_mfma_f32_16x16x32_bf16 a[192:195], v[28:31], a[152:155], a[192:195]
    s_add_u32 s6, s6, 128
    s_and_b32 s6, s6, 0x380
    s_add_u32 m0, s44, 4096
    s_add_u32 s70, s40, s6
    v_mfma_f32_32x32x16_bf16 v[160:175], a[32:35], a[156:159], v[160:175]
    ds_read_b128 a[44:47], v55 offset:8192
    ds_read_b128 a[144:147], v59 offset:16384
    buffer_load_dwordx4 v4, s[8:11], s70 offen offset:0 lds
    buffer_load_dwordx4 v5, s[8:11], s70 offen offset:1024 lds
    v_mfma_f32_16x16x32_bf16 a[196:199], v[28:31], a[156:159], a[196:199]
    s_cmp_eq_u32 s65, 2
    s_cbranch_scc1 L_xc2
L_nx2:
    s_waitcnt lgkmcnt(5)
    v_mfma_f32_32x32x16_bf16 v[144:159], a[36:39], a[128:131], v[144:159]
    ds_read_b128 a[148:151], v59 offset:20480
    buffer_load_dwordx4 v6, s[8:11], s70 offen offset:2048 lds
    v_mfma_f32_32x32x16_bf16 v[160:175], a[36:39], a[132:135], v[160:175]
    s_waitcnt vmcnt(9)
    s_barrier
    ds_read_b128 a[48:51], v52 offset:12288
    ds_read_b128 a[152:155], v56 offset:24576
    s_waitcnt lgkmcnt(5)
    v_mfma_f32_32x32x16_bf16 v[144:159], a[40:43], a[136:139], v[144:159]
    ds_read_b128 a[156:159], v56 offset:28672
    buffer_load_dwordx4 v7, s[8:11], s70 offen offset:3072 lds
    v_mfma_f32_32x32x16_bf16 v[160:175], a[40:43], a[140:143], v[160:175]
    ds_read_b128 a[52:55], v53 offset:12288
    ds_read_b128 a[128:131], v57 offset:24576
    s_add_u32 m0, s45, 8192
    s_add_u32 s70, s41, s6
    buffer_load_dwordx4 v4, s[12:15], s70 offen offset:0 lds
    s_waitcnt lgkmcnt(5)
    v_mfma_f32_32x32x16_bf16 v[144:159], a[44:47], a[144:147], v[144:159]
    ds_read_b128 a[132:135], v57 offset:28672
    v_mfma_f32_32x32x16_bf16 v[160:175], a[44:47], a[148:151], v[160:175]
    ds_read_b128 a[56:59], v54 offset:12288
    ds_read_b128 a[136:139], v58 offset:24576
    buffer_load_dwordx4 v5, s[12:15], s70 offen offset:1024 lds
    s_add_u32 s6, s6, 128
    s_and_b32 s6, s6, 0x380
    s_add_u32 m0, s44, 8192
    s_add_u32 s70, s40, s6
    s_waitcnt lgkmcnt(5)
    v_mfma_f32_32x32x16_bf16 v[144:159], a[48:51], a[152:155], v[144:159]
    ds_read_b128 a[140:143], v58 offset:28672
    buffer_load_dwordx4 v4, s[8:11], s70 offen offset:0 lds
    v_mfma_f32_16x16x32_bf16 a[192:195], v[28:31], a[152:155], a[192:195]
    v_mfma_f32_32x32x16_bf16 v[160:175], a[48:51], a[156:159], v[160:175]
    ds_read_b128 a[60:63], v55 offset:12288
    ds_read_b128 a[144:147], v59 offset:24576
    buffer_load_dwordx4 v5, s[8:11], s70 offen offset:1024 lds
    v_mfma_f32_16x16x32_bf16 a[196:199], v[28:31], a[156:159], a[196:199]
    s_cmp_eq_u32 s65, 3
    s_cbranch_scc1 L_xc3
L_nx3:
    s_waitcnt lgkmcnt(5)
    v_mfma_f32_32x32x16_bf16 v[144:159], a[52:55], a[128:131], v[144:159]
    ds_read_b128 a[148:151], v59 offset:28672
    buffer_load_dwordx4 v6, s[8:11], s70 offen offset:2048 lds
    v_mfma_f32_32x32x16_bf16 v[160:175], a[52:55], a[132:135], v[160:175]
    s_waitcnt vmcnt(9)
    s_barrier
    ds_read_b128 a[64:67], v52 offset:0
    ds_read_b128 a[152:155], v56 offset:0
    s_waitcnt lgkmcnt(5)
    v_mfma_f32_32x32x16_bf16 v[144:159], a[56:59], a[136:139], v[144:159]
    ds_read_b128 a[156:159], v56 offset:4096
    buffer_load_dwordx4 v7, s[8:11], s70 offen offset:3072 lds
    v_mfma_f32_32x32x16_bf16 v[160:175], a[56:59], a[140:143], v[160:175]
    ds_read_b128 a[68:71], v53 offset:0
    ds_read_b128 a[128:131], v57 offset:0
    s_add_u32 m0, s45, 16384
    s_add_u32 s70, s41, s6
    buffer_load_dwordx4 v4, s[12:15], s70 offen offset:0 lds
    s_waitcnt lgkmcnt(5)
    v_mfma_f32_32x32x16_bf16 v[144:159], a[60:63], a[144:147], v[144:159]
    ds_read_b128 a[132:135], v57 offset:4096
    v_mfma_f32_32x32x16_bf16 v[160:175], a[60:63], a[148:151], v[160:175]
    ds_read_b128 a[72:75], v54 offset:0
    ds_read_b128 a[136:139], v58 offset:0
    buffer_load_dwordx4 v5, s[12:15], s70 offen offset:1024 lds
    buffer_load_dwordx4 v[96:99], v66, s[20:23], s66 offen sc1
    buffer_load_dwordx2 v[110:111], v67, s[20:23], s76 offen offset:8 sc1
    s_waitcnt lgkmcnt(5)
    v_mfma_f32_32x32x16_bf16 v[144:159], a[64:67], a[152:155], v[144:159]
    ds_read_b128 a[140:143], v58 offset:4096
    s_add_u32 s6, s6, 128
    s_and_b32 s6, s6, 0x380
    s_add_u32 m0, s44, 12288
    s_add_u32 s70, s40, s6
    buffer_load_dwordx4 v4, s[8:11], s70 offen offset:0 lds
    v_mfma_f32_16x16x32_bf16 a[192:195], v[28:31], a[152:155], a[192:195]
    v_mfma_f32_32x32x16_bf16 v[160:175], a[64:67], a[156:159], v[160:175]
    ds_read_b128 a[76:79], v55 offset:0
    ds_read_b128 a[144:147], v59 offset:0
    buffer_load_dwordx4 v5, s[8:11], s70 offen offset:1024 lds
    v_mfma_f32_16x16x32_bf16 a[196:199], v[28:31], a[156:159], a[196:199]
    s_cmp_eq_u32 s65, 4
    s_cbranch_scc1 L_xc4
L_nx4:
    s_waitcnt lgkmcnt(5)
    v_mfma_f32_32x32x16_bf16 v[144:159], a[68:71], a[128:131], v[144:159]
    ds_read_b128 a[148:151], v59 offset:4096
    buffer_load_dwordx4 v6, s[8:11], s70 offen offset:2048 lds
    v_mfma_f32_32x32x16_bf16 v[160:175], a[68:71], a[132:135], v[160:175]
    s_waitcnt vmcnt(11)
    s_barrier
    ds_read_b128 a[80:83], v52 offset:4096
    ds_read_b128 a[152:155], v56 offset:8192
    s_waitcnt lgkmcnt(5)
    v_mfma_f32_32x32x16_bf16 v[144:159], a[72:75], a[136:139], v[144:159]
    ds_read_b128 a[156:159], v56 offset:12288
    buffer_load_dwordx4 v7, s[8:11], s70 offen offset:3072 lds
    v_mfma_f32_32x32x16_bf16 v[160:175], a[72:75], a[140:143], v[160:175]
    ds_read_b128 a[84:87], v53 offset:4096
    ds_read_b128 a[128:131], v57 offset:8192
    s_add_u32 m0, s45, 24576
    s_add_u32 s70, s41, s6
    buffer_load_dwordx4 v4, s[12:15], s70 offen offset:0 lds
    s_waitcnt lgkmcnt(5)
    v_mfma_f32_32x32x16_bf16 v[144:159], a[76:79], a[144:147], v[144:159]
    ds_read_b128 a[132:135], v57 offset:12288
    v_mfma_f32_32x32x16_bf16 v[160:175], a[76:79], a[148:151], v[160:175]
    ds_read_b128 a[88:91], v54 offset:4096
    ds_read_b128 a[136:139], v58 offset:8192
    buffer_load_dwordx4 v5, s[12:15], s70 offen offset:1024 lds
    s_waitcnt lgkmcnt(5)
    v_mfma_f32_32x32x16_bf16 v[144:159], a[80:83], a[152:155], v[144:159]
    ds_read_b128 a[140:143], v58 offset:12288
    s_and_b32 s75, s3, 3
    s_lshl_b32 s75, s75, 12
    s_add_u32 s44, s44, s75
    s_lshr_b32 s75, s75, 9
    s_lshr_b32 s40, 0x9372b1e4, s75
    v_mfma_f32_16x16x32_bf16 a[192:195], v[28:31], a[152:155], a[192:195]
    s_and_b32 s75, s51, 1
    s_lshl_b32 s75, s75, 6
    v_xor_b32 v4, s75, v4
    v_xor_b32 v5, s75, v5
    v_xor_b32 v6, s75, v6
    v_xor_b32 v7, s75, v7
    s_cmp_eq_u32 s5, 0
    s_cselect_b32 s8, s24, s28
    s_cselect_b32 s9, s25, s29
    s_cmp_lt_u32 s5, 2
    s_cselect_b32 s8, s8, s32
    s_cselect_b32 s9, s9, s33
    s_cselect_b32 s10, s26, s34
    buffer_load_dword v47, v89, s[8:11], 0 offen
    s_add_u32 s6, s6, 256
    s_and_b32 s6, s6, 0x380
    s_mul_i32 s7, s6, 1376
    s_add_u32 m0, s46, 12288
    s_add_u32 s70, s42, s7
    buffer_load_dwordx4 v80, s[16:19], s70 offen offset:0 lds
    v_mfma_f32_32x32x16_bf16 v[160:175], a[80:83], a[156:159], v[160:175]
    ds_read_b128 a[92:95], v55 offset:4096
    ds_read_b128 a[144:147], v59 offset:8192
    v_mfma_f32_16x16x32_bf16 a[196:199], v[28:31], a[156:159], a[196:199]
    s_cmp_eq_u32 s65, 5
    s_cbranch_scc1 L_xc5
L_nx5:
    s_waitcnt lgkmcnt(5)
    v_mfma_f32_32x32x16_bf16 v[144:159], a[84:87], a[128:131], v[144:159]
    ds_read_b128 a[148:151], v59 offset:12288
    buffer_load_dwordx4 v81, s[16:19], s70 offen offset:1024 lds
    v_mfma_f32_32x32x16_bf16 v[160:175], a[84:87], a[132:135], v[160:175]
    s_waitcnt vmcnt(11)
    s_barrier
    ds_read_b128 a[96:99], v52 offset:8192
    ds_read_b128 a[152:155], v56 offset:16384
    s_waitcnt lgkmcnt(5)
    v_mfma_f32_32x32x16_bf16 v[144:159], a[88:91], a[136:139], v[144:159]
    ds_read_b128 a[156:159], v56 offset:20480
    v_mfma_f32_32x32x16_bf16 v[160:175], a[88:91], a[140:143], v[160:175]
    ds_read_b128 a[100:103], v53 offset:8192
    ds_read_b128 a[128:131], v57 offset:16384
    buffer_load_dwordx4 v82, s[16:19], s70 offen offset:2048 lds
    s_waitcnt lgkmcnt(5)
    v_mfma_f32_32x32x16_bf16 v[144:159], a[92:95], a[144:147], v[144:159]
    ds_read_b128 a[132:135], v57 offset:20480
    v_mfma_f32_32x32x16_bf16 v[160:175], a[92:95], a[148:151], v[160:175]
    ds_read_b128 a[104:107], v54 offset:8192
    ds_read_b128 a[136:139], v58 offset:16384
    s_waitcnt lgkmcnt(5)
    v_mfma_f32_32x32x16_bf16 v[144:159], a[96:99], a[152:155], v[144:159]
    ds_read_b128 a[140:143], v58 offset:20480
    s_add_u32 s6, s6, 128
    s_and_b32 s6, s6, 0x380
    s_mul_i32 s7, s6, 1376
    s_add_u32 m0, s46, 24576
    s_add_u32 s70, s42, s7
    buffer_load_dwordx4 v80, s[16:19], s70 offen offset:0 lds
    v_mfma_f32_16x16x32_bf16 a[192:195], v[28:31], a[152:155], a[192:195]
    s_waitcnt vmcnt(12)
    v_cmp_ne_u32_e64 s[88:89], v98, s52
    s_nop 1
    s_cmp_lg_u64 s[88:89], 0
    s_cbranch_scc1 L_slow_st
L_ok_st:
    v_and_b32 v102, 0xffff0000, v96
    v_mfma_f32_32x32x16_bf16 v[160:175], a[96:99], a[156:159], v[160:175]
    ds_read_b128 a[108:111], v55 offset:8192
    ds_read_b128 a[144:147], v59 offset:16384
    v_and_b32 v104, 0xffff0000, v97
    v_rcp_f32 v105, v102
    v_mul_f32 v250, v102, v104
    v_lshlrev_b32 v101, 16, v96
    v_rcp_f32 v106, v250
    v_mfma_f32_16x16x32_bf16 a[196:199], v[28:31], a[156:159], a[196:199]
    buffer_load_dwordx4 v81, s[16:19], s70 offen offset:1024 lds
    s_cmp_eq_u32 s65, 6
    s_cbranch_scc1 L_xc6
L_nx6:
    s_waitcnt lgkmcnt(5)
    v_mfma_f32_32x32x16_bf16 v[144:159], a[100:103], a[128:131], v[144:159]
    ds_read_b128 a[148:151], v59 offset:20480
    v_lshlrev_b32 v103, 16, v97
    ds_write_b32 v88, v105
    v_mul_f32 v105, v105, v101
    ds_write_b32 v88, v105 offset:128
    s_waitcnt vmcnt(12)
    v_cmp_ne_u64_e64 s[54:55], v[110:111], s[78:79]
    v_fma_f32 v107, -v103, v102, -v101
    v_cvt_pk_bf16_f32 v247, -v101, -v101
    v_mfma_f32_32x32x16_bf16 v[160:175], a[100:103], a[132:135], v[160:175]
    s_waitcnt vmcnt(6)
    s_barrier
    ds_read_b128 a[112:115], v52 offset:12288
    ds_read_b128 a[152:155], v56 offset:24576
    s_waitcnt lgkmcnt(7)
    v_mfma_f32_32x32x16_bf16 v[144:159], a[104:107], a[136:139], v[144:159]
    ds_read_b128 a[156:159], v56 offset:28672
    buffer_load_dwordx4 v82, s[16:19], s70 offen offset:2048 lds
    v_cvt_pk_bf16_f32 v244, v107, v107
    v_cvt_pk_bf16_f32 v102, v250, v250
    v_lshlrev_b32 v103, 16, v244
    v_lshlrev_b32 v102, 16, v102
    v_sub_f32 v103, v107, v103
    v_mfma_f32_32x32x16_bf16 v[160:175], a[104:107], a[140:143], v[160:175]
    ds_read_b128 a[116:119], v53 offset:12288
    ds_read_b128 a[128:131], v57 offset:24576
    v_sub_f32 v102, v250, v102
    v_cvt_pk_bf16_f32 v245, v103, v103
    v_cvt_pk_bf16_f32 v246, v250, v102
    v_mul_f32 v248, 0xc0135761, v106
    v_mul_f32 v102, v106, v106
    s_waitcnt lgkmcnt(7)
    v_mfma_f32_32x32x16_bf16 v[144:159], a[108:111], a[144:147], v[144:159]
    ds_read_b128 a[132:135], v57 offset:28672
    v_mul_f32 v249, 0xbdd2d3e8, v106
    v_mul_f32 v249, v249, v102
    v_mfma_f32_32x32x16_bf16 v[160:175], a[108:111], a[148:151], v[160:175]
    ds_read_b128 a[120:123], v54 offset:12288
    ds_read_b128 a[136:139], v58 offset:24576
    ds_read_b128 v[116:119], v251 offset:0
    ds_read_b128 v[120:123], v251 offset:16
    ds_read_b128 v[124:127], v251 offset:32
    ds_read_b128 v[128:131], v251 offset:48
    s_waitcnt lgkmcnt(9)
    v_mfma_f32_32x32x16_bf16 v[144:159], a[112:115], a[152:155], v[144:159]
    ds_read_b128 a[140:143], v58 offset:28672
    s_add_u32 s6, s6, 128
    s_and_b32 s6, s6, 0x380
    s_mul_i32 s7, s6, 1376
    s_add_u32 m0, s46, 36864
    s_add_u32 s70, s42, s7
    buffer_load_dwordx4 v80, s[16:19], s70 offen offset:0 lds
    v_mfma_f32_16x16x32_bf16 a[192:195], v[28:31], a[152:155], a[192:195]
    s_add_u32 s8, s77, 8192
    s_add_u32 s9, s77, 16384
    s_add_u32 s10, s77, 20480
    s_add_u32 s11, s77, 22528
    v_mfma_f32_32x32x16_bf16 v[160:175], a[112:115], a[156:159], v[160:175]
    ds_read_b128 a[124:127], v55 offset:12288
    ds_read_b128 a[144:147], v59 offset:24576
    s_add_u32 s12, s77, 30720
    s_add_u32 s13, s64, 8192
    s_add_u32 s14, s64, 16384
    s_add_u32 s15, s64, 22528
    s_add_u32 s41, s64, 30720
    s_cmp_eq_u32 s51, 3
    s_cselect_b32 s14, 2146435072, s14
    v_mfma_f32_16x16x32_bf16 a[196:199], v[28:31], a[156:159], a[196:199]
    buffer_load_dwordx4 v81, s[16:19], s70 offen offset:1024 lds
    s_cmp_eq_u32 s65, 7
    s_cbranch_scc1 L_xc7
L_nx7:
    s_waitcnt lgkmcnt(9)
    v_mfma_f32_32x32x16_bf16 v[144:159], a[116:119], a[128:131], v[144:159]
    ds_read_b128 a[148:151], v59 offset:28672
    ds_write_b32 v139, a192 offset:0
    s_nop 0
    ds_write_b32 v139, a196 offset:512
    s_mov_b32 s79, s52
    v_mfma_f32_32x32x16_bf16 v[160:175], a[116:119], a[132:135], v[160:175]
    s_waitcnt lgkmcnt(0)
    s_barrier
    ds_read_b64_tr_b16 a[152:153], v85 offset:0
    ds_read_b64_tr_b16 a[154:155], v85 offset:768
    v_mfma_f32_32x32x16_bf16 v[144:159], a[120:123], a[136:139], v[144:159]
    ds_read_b64_tr_b16 a[156:157], v85 offset:64
    ds_read_b64_tr_b16 a[158:159], v85 offset:832
    ds_read_b64 v[90:91], v87 offset:0
    ds_read_b64 v[92:93], v87 offset:512
    buffer_load_dwordx4 v82, s[16:19], s70 offen offset:2048 lds
    v_mfma_f32_32x32x16_bf16 v[160:175], a[120:123], a[140:143], v[160:175]
    ds_read_b64_tr_b16 a[128:129], v85 offset:128
    ds_read_b64_tr_b16 a[130:131], v85 offset:896
    v_mfma_f32_32x32x16_bf16 v[144:159], a[124:127], a[144:147], v[144:159]
    ds_read_b64_tr_b16 a[132:133], v86 offset:0
    ds_read_b64_tr_b16 a[134:135], v86 offset:768
    s_waitcnt lgkmcnt(5)
    v_add_f32 v90, v90, v91
    v_cvt_pk_bf16_f32 v91, v90, v90
    v_lshlrev_b32 v91, 16, v91
    v_sub_f32 v91, v90, v91
    v_cvt_pk_bf16_f32 v227, v90, v91
    s_waitcnt lgkmcnt(4)
    v_add_f32 v92, v92, v93
    v_mfma_f32_32x32x16_bf16 v[160:175], a[124:127], a[148:151], v[160:175]
    ds_read_b64_tr_b16 a[136:137], v86 offset:64
    ds_read_b64_tr_b16 a[138:139], v86 offset:832
    v_cvt_pk_bf16_f32 v93, v92, v92
    v_lshlrev_b32 v93, 16, v93
    v_sub_f32 v93, v92, v93
    v_cvt_pk_bf16_f32 v231, v92, v93
    v_mfma_f32_32x32x16_bf16 v[144:159], v[244:247], v[224:227], v[144:159]
    s_nop 0
    v_mfma_f32_32x32x16_bf16 v[160:175], v[244:247], v[228:231], v[160:175]
    v_mfma_f32_32x32x16_bf16 v[176:191], a[152:155], a[8:11], v[176:191]
    ds_read_b64_tr_b16 a[140:141], v86 offset:128
    ds_read_b64_tr_b16 a[142:143], v86 offset:896
    s_nop 6
    v_pk_mul_f32 v[48:49], v[144:145], v[34:35] op_sel:[0,0] op_sel_hi:[0,1] neg_hi:[0,1]
    s_nop 0
    v_pk_fma_f32 v[48:49], v[160:161], v[34:35], v[48:49] op_sel:[0,1,0] op_sel_hi:[0,0,1] neg_lo:[0,1,0] neg_hi:[0,1,0]
    v_pk_mul_f32 v[48:49], v[48:49], v[116:117] op_sel:[0,0] op_sel_hi:[1,0]
    v_pk_mul_f32 v[50:51], v[144:145], v[34:35] op_sel:[1,0] op_sel_hi:[1,1] neg_hi:[0,1]
    v_pk_fma_f32 v[50:51], v[160:161], v[34:35], v[50:51] op_sel:[1,1,0] op_sel_hi:[1,0,1] neg_lo:[0,1,0] neg_hi:[0,1,0]
    v_pk_mul_f32 v[50:51], v[50:51], v[116:117] op_sel:[0,1] op_sel_hi:[1,1]
    v_pk_fma_f32 v[134:135], v[48:49], v[32:33], v[50:51] op_sel_hi:[1,0,1]
    v_pk_fma_f32 v[134:135], v[48:49], v[32:33], v[134:135] op_sel:[1,1,0] op_sel_hi:[0,1,1] neg_lo:[0,1,0]
    s_xor_b32 m0, s44, 0
    s_nop 0
    s_nop 0
    buffer_load_dwordx4 v4, s[24:27], s72 offen offset:0 lds
    v_pk_mul_f32 v[52:53], v[146:147], v[34:35] op_sel:[0,0] op_sel_hi:[0,1] neg_hi:[0,1]
    v_pk_fma_f32 v[52:53], v[162:163], v[34:35], v[52:53] op_sel:[0,1,0] op_sel_hi:[0,0,1] neg_lo:[0,1,0] neg_hi:[0,1,0]
    v_pk_mul_f32 v[52:53], v[52:53], v[118:119] op_sel:[0,0] op_sel_hi:[1,0]
    v_pk_fma_f32 v[132:133], v[134:135], v[32:33], v[52:53] op_sel_hi:[1,0,1]
    v_pk_fma_f32 v[132:133], v[134:135], v[32:33], v[132:133] op_sel:[1,1,0] op_sel_hi:[0,1,1] neg_lo:[0,1,0]
    v_pk_mul_f32 v[54:55], v[146:147], v[34:35] op_sel:[1,0] op_sel_hi:[1,1] neg_hi:[0,1]
    v_pk_fma_f32 v[54:55], v[162:163], v[34:35], v[54:55] op_sel:[1,1,0] op_sel_hi:[1,0,1] neg_lo:[0,1,0] neg_hi:[0,1,0]
    v_pk_mul_f32 v[54:55], v[54:55], v[118:119] op_sel:[0,1] op_sel_hi:[1,1]
    v_pk_fma_f32 v[134:135], v[132:133], v[32:33], v[54:55] op_sel_hi:[1,0,1]
    v_pk_fma_f32 v[134:135], v[132:133], v[32:33], v[134:135] op_sel:[1,1,0] op_sel_hi:[0,1,1] neg_lo:[0,1,0]
    v_pk_mul_f32 v[56:57], v[148:149], v[34:35] op_sel:[0,0] op_sel_hi:[0,1] neg_hi:[0,1]
    v_pk_fma_f32 v[56:57], v[164:165], v[34:35], v[56:57] op_sel:[0,1,0] op_sel_hi:[0,0,1] neg_lo:[0,1,0] neg_hi:[0,1,0]
    v_pk_mul_f32 v[56:57], v[56:57], v[120:121] op_sel:[0,0] op_sel_hi:[1,0]
    v_pk_fma_f32 v[132:133], v[134:135], v[32:33], v[56:57] op_sel_hi:[1,0,1]
    v_pk_fma_f32 v[132:133], v[134:135], v[32:33], v[132:133] op_sel:[1,1,0] op_sel_hi:[0,1,1] neg_lo:[0,1,0]
    v_pk_mul_f32 v[58:59], v[148:149], v[34:35] op_sel:[1,0] op_sel_hi:[1,1] neg_hi:[0,1]
    buffer_load_dwordx4 v5, s[24:27], s72 offen offset:1024 lds
    v_pk_fma_f32 v[58:59], v[164:165], v[34:35], v[58:59] op_sel:[1,1,0] op_sel_hi:[1,0,1] neg_lo:[0,1,0] neg_hi:[0,1,0]
    v_pk_mul_f32 v[58:59], v[58:59], v[120:121] op_sel:[0,1] op_sel_hi:[1,1]
    v_pk_fma_f32 v[134:135], v[132:133], v[32:33], v[58:59] op_sel_hi:[1,0,1]
    v_pk_fma_f32 v[134:135], v[132:133], v[32:33], v[134:135] op_sel:[1,1,0] op_sel_hi:[0,1,1] neg_lo:[0,1,0]
    v_pk_mul_f32 v[60:61], v[150:151], v[34:35] op_sel:[0,0] op_sel_hi:[0,1] neg_hi:[0,1]
    v_pk_fma_f32 v[60:61], v[166:167], v[34:35], v[60:61] op_sel:[0,1,0] op_sel_hi:[0,0,1] neg_lo:[0,1,0] neg_hi:[0,1,0]
    v_pk_mul_f32 v[60:61], v[60:61], v[122:123] op_sel:[0,0] op_sel_hi:[1,0]
    v_pk_fma_f32 v[132:133], v[134:135], v[32:33], v[60:61] op_sel_hi:[1,0,1]
    v_pk_fma_f32 v[132:133], v[134:135], v[32:33], v[132:133] op_sel:[1,1,0] op_sel_hi:[0,1,1] neg_lo:[0,1,0]
    v_pk_mul_f32 v[62:63], v[150:151], v[34:35] op_sel:[1,0] op_sel_hi:[1,1] neg_hi:[0,1]
    v_pk_fma_f32 v[62:63], v[166:167], v[34:35], v[62:63] op_sel:[1,1,0] op_sel_hi:[1,0,1] neg_lo:[0,1,0] neg_hi:[0,1,0]
    v_pk_mul_f32 v[62:63], v[62:63], v[122:123] op_sel:[0,1] op_sel_hi:[1,1]
    v_pk_fma_f32 v[134:135], v[132:133], v[32:33], v[62:63] op_sel_hi:[1,0,1]
    v_pk_fma_f32 v[134:135], v[132:133], v[32:33], v[134:135] op_sel:[1,1,0] op_sel_hi:[0,1,1] neg_lo:[0,1,0]
    v_pk_mul_f32 v[64:65], v[152:153], v[34:35] op_sel:[0,0] op_sel_hi:[0,1] neg_hi:[0,1]
    v_pk_fma_f32 v[64:65], v[168:169], v[34:35], v[64:65] op_sel:[0,1,0] op_sel_hi:[0,0,1] neg_lo:[0,1,0] neg_hi:[0,1,0]
    buffer_load_dwordx4 v6, s[24:27], s72 offen offset:2048 lds
    v_pk_mul_f32 v[64:65], v[64:65], v[124:125] op_sel:[0,0] op_sel_hi:[1,0]
    v_pk_fma_f32 v[132:133], v[134:135], v[32:33], v[64:65] op_sel_hi:[1,0,1]
    v_pk_fma_f32 v[132:133], v[134:135], v[32:33], v[132:133] op_sel:[1,1,0] op_sel_hi:[0,1,1] neg_lo:[0,1,0]
    v_pk_mul_f32 v[66:67], v[152:153], v[34:35] op_sel:[1,0] op_sel_hi:[1,1] neg_hi:[0,1]
    v_pk_fma_f32 v[66:67], v[168:169], v[34:35], v[66:67] op_sel:[1,1,0] op_sel_hi:[1,0,1] neg_lo:[0,1,0] neg_hi:[0,1,0]
    v_pk_mul_f32 v[66:67], v[66:67], v[124:125] op_sel:[0,1] op_sel_hi:[1,1]
    v_pk_fma_f32 v[134:135], v[132:133], v[32:33], v[66:67] op_sel_hi:[1,0,1]
    v_pk_fma_f32 v[134:135], v[132:133], v[32:33], v[134:135] op_sel:[1,1,0] op_sel_hi:[0,1,1] neg_lo:[0,1,0]
    v_pk_mul_f32 v[68:69], v[154:155], v[34:35] op_sel:[0,0] op_sel_hi:[0,1] neg_hi:[0,1]
    v_pk_fma_f32 v[68:69], v[170:171], v[34:35], v[68:69] op_sel:[0,1,0] op_sel_hi:[0,0,1] neg_lo:[0,1,0] neg_hi:[0,1,0]
    v_pk_mul_f32 v[68:69], v[68:69], v[126:127] op_sel:[0,0] op_sel_hi:[1,0]
    v_pk_fma_f32 v[132:133], v[134:135], v[32:33], v[68:69] op_sel_hi:[1,0,1]
    v_pk_fma_f32 v[132:133], v[134:135], v[32:33], v[132:133] op_sel:[1,1,0] op_sel_hi:[0,1,1] neg_lo:[0,1,0]
    v_pk_mul_f32 v[70:71], v[154:155], v[34:35] op_sel:[1,0] op_sel_hi:[1,1] neg_hi:[0,1]
    v_pk_fma_f32 v[70:71], v[170:171], v[34:35], v[70:71] op_sel:[1,1,0] op_sel_hi:[1,0,1] neg_lo:[0,1,0] neg_hi:[0,1,0]
    buffer_load_dwordx4 v7, s[24:27], s72 offen offset:3072 lds
    v_pk_mul_f32 v[70:71], v[70:71], v[126:127] op_sel:[0,1] op_sel_hi:[1,1]
    v_pk_fma_f32 v[134:135], v[132:133], v[32:33], v[70:71] op_sel_hi:[1,0,1]
    v_pk_fma_f32 v[134:135], v[132:133], v[32:33], v[134:135] op_sel:[1,1,0] op_sel_hi:[0,1,1] neg_lo:[0,1,0]
    v_pk_mul_f32 v[72:73], v[156:157], v[34:35] op_sel:[0,0] op_sel_hi:[0,1] neg_hi:[0,1]
    v_pk_fma_f32 v[72:73], v[172:173], v[34:35], v[72:73] op_sel:[0,1,0] op_sel_hi:[0,0,1] neg_lo:[0,1,0] neg_hi:[0,1,0]
    v_pk_mul_f32 v[72:73], v[72:73], v[128:129] op_sel:[0,0] op_sel_hi:[1,0]
    v_pk_fma_f32 v[132:133], v[134:135], v[32:33], v[72:73] op_sel_hi:[1,0,1]
    v_pk_fma_f32 v[132:133], v[134:135], v[32:33], v[132:133] op_sel:[1,1,0] op_sel_hi:[0,1,1] neg_lo:[0,1,0]
    v_pk_mul_f32 v[74:75], v[156:157], v[34:35] op_sel:[1,0] op_sel_hi:[1,1] neg_hi:[0,1]
    v_pk_fma_f32 v[74:75], v[172:173], v[34:35], v[74:75] op_sel:[1,1,0] op_sel_hi:[1,0,1] neg_lo:[0,1,0] neg_hi:[0,1,0]
    v_pk_mul_f32 v[74:75], v[74:75], v[128:129] op_sel:[0,1] op_sel_hi:[1,1]
    v_pk_fma_f32 v[134:135], v[132:133], v[32:33], v[74:75] op_sel_hi:[1,0,1]
    v_pk_fma_f32 v[134:135], v[132:133], v[32:33], v[134:135] op_sel:[1,1,0] op_sel_hi:[0,1,1] neg_lo:[0,1,0]
    v_pk_mul_f32 v[76:77], v[158:159], v[34:35] op_sel:[0,0] op_sel_hi:[0,1] neg_hi:[0,1]
    v_pk_fma_f32 v[76:77], v[174:175], v[34:35], v[76:77] op_sel:[0,1,0] op_sel_hi:[0,0,1] neg_lo:[0,1,0] neg_hi:[0,1,0]
    v_pk_mul_f32 v[76:77], v[76:77], v[130:131] op_sel:[0,0] op_sel_hi:[1,0]
    buffer_load_dword v47, v24, s[20:23], s74 offen
    v_pk_fma_f32 v[132:133], v[134:135], v[32:33], v[76:77] op_sel_hi:[1,0,1]
    v_pk_fma_f32 v[132:133], v[134:135], v[32:33], v[132:133] op_sel:[1,1,0] op_sel_hi:[0,1,1] neg_lo:[0,1,0]
    v_pk_mul_f32 v[78:79], v[158:159], v[34:35] op_sel:[1,0] op_sel_hi:[1,1] neg_hi:[0,1]
    v_pk_fma_f32 v[78:79], v[174:175], v[34:35], v[78:79] op_sel:[1,1,0] op_sel_hi:[1,0,1] neg_lo:[0,1,0] neg_hi:[0,1,0]
    v_pk_mul_f32 v[78:79], v[78:79], v[130:131] op_sel:[0,1] op_sel_hi:[1,1]
    v_pk_fma_f32 v[134:135], v[132:133], v[32:33], v[78:79] op_sel_hi:[1,0,1]
    v_pk_fma_f32 v[134:135], v[132:133], v[32:33], v[134:135] op_sel:[1,1,0] op_sel_hi:[0,1,1] neg_lo:[0,1,0]
    ds_write_b64 v19, v[134:135] offset:1792
    v_mfma_f32_32x32x16_bf16 v[192:207], a[156:159], a[8:11], v[192:207]
    v_mov_b32 v114, s52
    v_mov_b32 v115, s53
    s_waitcnt vmcnt(11) lgkmcnt(0)
    s_barrier
    ds_read_b64_tr_b16 a[144:145], v83 offset:12288
    ds_read_b64_tr_b16 a[146:147], v83 offset:13056
    ds_read_b64 v[160:161], v19 offset:0
    ds_read_b64 v[162:163], v19 offset:256
    ds_read_b64 v[164:165], v19 offset:512
    ds_read_b64 v[166:167], v19 offset:768
    ds_read_b64 v[168:169], v19 offset:1024
    ds_read_b64 v[170:171], v19 offset:1280
    ds_read_b64 v[172:173], v19 offset:1536
    v_mfma_f32_32x32x16_bf16 v[208:223], a[128:131], a[8:11], v[208:223]
    ds_read_b64_tr_b16 a[148:149], v83 offset:12352
    ds_read_b64_tr_b16 a[150:151], v83 offset:13120
    s_bfe_u32 s75, s40, 0x20000
    s_lshl_b32 s70, s75, 13
    s_add_u32 m0, s70, s45
    s_add_u32 s70, s60, 49152
    buffer_load_dwordx4 v136, s[32:35], s70 offen offset:0 lds
    v_mfma_f32_32x32x16_bf16 v[176:191], a[132:135], a[12:15], v[176:191]
    ds_read_b64_tr_b16 a[152:153], v83 offset:12416
    ds_read_b64_tr_b16 a[154:155], v83 offset:13184
    v_mfma_f32_32x32x16_bf16 v[192:207], a[136:139], a[12:15], v[192:207]
    ds_read_b64_tr_b16 a[156:157], v84 offset:12288
    ds_read_b64_tr_b16 a[158:159], v84 offset:13056
    s_bfe_u32 s75, s40, 0x20000
    s_and_b32 s70, s75, 2
    s_lshl1_add_u32 s70, s70, s75
    s_lshl_b32 s70, s70, 14
    s_add_u32 s70, s70, s95
    buffer_load_dwordx4 v137, s[32:35], s70 offen offset:1024 lds
    s_waitcnt lgkmcnt(11)
    v_pk_fma_f32 v[162:163], v[160:161], v[36:37], v[162:163] op_sel_hi:[1,0,1]
    v_pk_fma_f32 v[162:163], v[160:161], v[36:37], v[162:163] op_sel:[1,1,0] op_sel_hi:[0,1,1] neg_lo:[0,1,0]
    s_waitcnt lgkmcnt(10)
    v_pk_fma_f32 v[164:165], v[162:163], v[36:37], v[164:165] op_sel_hi:[1,0,1]
    v_pk_fma_f32 v[164:165], v[162:163], v[36:37], v[164:165] op_sel:[1,1,0] op_sel_hi:[0,1,1] neg_lo:[0,1,0]
    s_waitcnt lgkmcnt(9)
    v_pk_fma_f32 v[166:167], v[164:165], v[36:37], v[166:167] op_sel_hi:[1,0,1]
    v_pk_fma_f32 v[166:167], v[164:165], v[36:37], v[166:167] op_sel:[1,1,0] op_sel_hi:[0,1,1] neg_lo:[0,1,0]
    s_waitcnt lgkmcnt(8)
    v_pk_fma_f32 v[168:169], v[166:167], v[36:37], v[168:169] op_sel_hi:[1,0,1]
    v_pk_fma_f32 v[168:169], v[166:167], v[36:37], v[168:169] op_sel:[1,1,0] op_sel_hi:[0,1,1] neg_lo:[0,1,0]
    s_waitcnt lgkmcnt(7)
    v_pk_fma_f32 v[170:171], v[168:169], v[36:37], v[170:171] op_sel_hi:[1,0,1]
    v_pk_fma_f32 v[170:171], v[168:169], v[36:37], v[170:171] op_sel:[1,1,0] op_sel_hi:[0,1,1] neg_lo:[0,1,0]
    s_waitcnt lgkmcnt(6)
    v_pk_fma_f32 v[132:133], v[170:171], v[36:37], v[172:173] op_sel_hi:[1,0,1]
    v_pk_fma_f32 v[132:133], v[170:171], v[36:37], v[132:133] op_sel:[1,1,0] op_sel_hi:[0,1,1] neg_lo:[0,1,0]
    v_pk_fma_f32 v[112:113], v[132:133], v[36:37], v[134:135] op_sel_hi:[1,0,1]
    v_pk_fma_f32 v[112:113], v[132:133], v[36:37], v[112:113] op_sel:[1,1,0] op_sel_hi:[0,1,1] neg_lo:[0,1,0]
    buffer_store_dwordx4 v[112:115], v20, s[84:87], s0 offen sc1
    v_mfma_f32_32x32x16_bf16 v[208:223], a[140:143], a[12:15], v[208:223]
    ds_read_b64_tr_b16 a[128:129], v84 offset:12352
    ds_read_b64_tr_b16 a[130:131], v84 offset:13120
    s_waitcnt lgkmcnt(6)
    v_mfma_f32_32x32x16_bf16 v[176:191], a[144:147], a[16:19], v[176:191]
    ds_read_b64_tr_b16 a[132:133], v84 offset:12416
    ds_read_b64_tr_b16 a[134:135], v84 offset:13184
    s_add_u32 m0, s45, 32768
    s_add_u32 s70, s71, 262144
    buffer_load_dwordx4 v136, s[32:35], s70 offen offset:0 lds
    v_mfma_f32_16x16x32_bf16 a[200:203], v[28:31], a[144:147], a[200:203]
    v_mfma_f32_32x32x16_bf16 v[192:207], a[148:151], a[16:19], v[192:207]
    ds_read_b64_tr_b16 a[136:137], v85 offset:12288
    ds_read_b64_tr_b16 a[138:139], v85 offset:13056
    buffer_load_dwordx4 v137, s[32:35], s70 offen offset:1024 lds
    v_mfma_f32_16x16x32_bf16 a[204:207], v[28:31], a[148:151], a[204:207]
    s_waitcnt lgkmcnt(6)
    v_mfma_f32_32x32x16_bf16 v[208:223], a[152:155], a[16:19], v[208:223]
    ds_read_b64_tr_b16 a[140:141], v85 offset:12352
    ds_read_b64_tr_b16 a[142:143], v85 offset:13120
    s_xor_b32 m0, s44, 4096
    s_nop 0
    buffer_load_dwordx4 v4, s[24:27], s73 offen offset:0 lds
    v_mfma_f32_16x16x32_bf16 a[208:211], v[28:31], a[152:155], a[208:211]
    v_mfma_f32_32x32x16_bf16 v[176:191], a[156:159], a[20:23], v[176:191]
    ds_read_b64_tr_b16 a[144:145], v85 offset:12416
    ds_read_b64_tr_b16 a[146:147], v85 offset:13184
    buffer_load_dwordx4 v5, s[24:27], s73 offen offset:1024 lds
    s_waitcnt lgkmcnt(6)
    v_mfma_f32_32x32x16_bf16 v[192:207], a[128:131], a[20:23], v[192:207]
    ds_read_b64_tr_b16 a[148:149], v86 offset:12288
    ds_read_b64_tr_b16 a[150:151], v86 offset:13056
    v_mfma_f32_32x32x16_bf16 v[208:223], a[132:135], a[20:23], v[208:223]
    ds_read_b64_tr_b16 a[152:153], v86 offset:12352
    ds_read_b64_tr_b16 a[154:155], v86 offset:13120
    buffer_load_dwordx4 v6, s[24:27], s73 offen offset:2048 lds
    s_waitcnt lgkmcnt(6)
    v_mfma_f32_32x32x16_bf16 v[176:191], a[136:139], a[24:27], v[176:191]
    ds_read_b64_tr_b16 a[156:157], v86 offset:12416
    ds_read_b64_tr_b16 a[158:159], v86 offset:13184
    v_mfma_f32_32x32x16_bf16 v[192:207], a[140:143], a[24:27], v[192:207]
    s_waitcnt vmcnt(16)
    s_barrier
    ds_read_b64_tr_b16 a[128:129], v83 offset:24576
    ds_read_b64_tr_b16 a[130:131], v83 offset:25344
    buffer_load_dwordx4 v7, s[24:27], s73 offen offset:3072 lds
    s_waitcnt lgkmcnt(6)
    v_mfma_f32_32x32x16_bf16 v[208:223], a[144:147], a[24:27], v[208:223]
    ds_read_b64_tr_b16 a[132:133], v83 offset:24640
    ds_read_b64_tr_b16 a[134:135], v83 offset:25408
    v_mfma_f32_32x32x16_bf16 v[176:191], a[148:151], a[28:31], v[176:191]
    ds_read_b64_tr_b16 a[136:137], v83 offset:24704
    ds_read_b64_tr_b16 a[138:139], v83 offset:25472
    s_add_u32 s6, s6, 128
    s_and_b32 s6, s6, 0x380
    s_mul_i32 s7, s6, 1376
    s_add_u32 m0, s46, 0
    s_add_u32 s70, s42, s7
    buffer_load_dwordx4 v80, s[16:19], s70 offen offset:0 lds
    s_waitcnt lgkmcnt(6)
    v_mfma_f32_32x32x16_bf16 v[192:207], a[152:155], a[28:31], v[192:207]
    ds_read_b64_tr_b16 a[140:141], v84 offset:24576
    ds_read_b64_tr_b16 a[142:143], v84 offset:25344
    v_mfma_f32_32x32x16_bf16 v[208:223], a[156:159], a[28:31], v[208:223]
    ds_read_b64_tr_b16 a[144:145], v84 offset:24640
    ds_read_b64_tr_b16 a[146:147], v84 offset:25408
    s_waitcnt lgkmcnt(6)
    v_mfma_f32_32x32x16_bf16 v[176:191], a[128:131], a[32:35], v[176:191]
    ds_read_b64_tr_b16 a[148:149], v84 offset:24704
    ds_read_b64_tr_b16 a[150:151], v84 offset:25472
    buffer_load_dwordx4 v81, s[16:19], s70 offen offset:1024 lds
    v_mfma_f32_16x16x32_bf16 a[200:203], v[28:31], a[128:131], a[200:203]
    v_mfma_f32_32x32x16_bf16 v[192:207], a[132:135], a[32:35], v[192:207]
    ds_read_b64_tr_b16 a[152:153], v85 offset:24576
    ds_read_b64_tr_b16 a[154:155], v85 offset:25344
    v_mfma_f32_16x16x32_bf16 a[204:207], v[28:31], a[132:135], a[204:207]
    buffer_load_dwordx4 v82, s[16:19], s70 offen offset:2048 lds
    s_waitcnt lgkmcnt(6)
    v_mfma_f32_32x32x16_bf16 v[208:223], a[136:139], a[32:35], v[208:223]
    ds_read_b64_tr_b16 a[156:157], v85 offset:24640
    ds_read_b64_tr_b16 a[158:159], v85 offset:25408
    v_mfma_f32_16x16x32_bf16 a[208:211], v[28:31], a[136:139], a[208:211]
    v_mfma_f32_32x32x16_bf16 v[176:191], a[140:143], a[36:39], v[176:191]
    ds_read_b64_tr_b16 a[128:129], v85 offset:24704
    ds_read_b64_tr_b16 a[130:131], v85 offset:25472
    s_and_b32 s75, s3, 1
    s_lshl_b32 s75, s75, 7
    s_xor_b32 s72, s72, s75
    s_xor_b32 s73, s72, 128
    s_andn2_b32 s44, s44, 0x1000
    s_xor_b32 m0, s44, 8192
    s_nop 0
    buffer_load_dwordx4 v4, s[28:31], s72 offen offset:0 lds
    s_waitcnt lgkmcnt(6)
    v_mfma_f32_32x32x16_bf16 v[192:207], a[144:147], a[36:39], v[192:207]
    ds_read_b64_tr_b16 a[132:133], v86 offset:24576
    ds_read_b64_tr_b16 a[134:135], v86 offset:25344
    v_mfma_f32_32x32x16_bf16 v[208:223], a[148:151], a[36:39], v[208:223]
    ds_read_b64_tr_b16 a[136:137], v86 offset:24640
    ds_read_b64_tr_b16 a[138:139], v86 offset:25408
    buffer_load_dwordx4 v5, s[28:31], s72 offen offset:1024 lds
    s_waitcnt lgkmcnt(6)
    v_mfma_f32_32x32x16_bf16 v[176:191], a[152:155], a[40:43], v[176:191]
    ds_read_b64_tr_b16 a[140:141], v86 offset:24704
    ds_read_b64_tr_b16 a[142:143], v86 offset:25472
    v_mfma_f32_32x32x16_bf16 v[192:207], a[156:159], a[40:43], v[192:207]
    s_waitcnt vmcnt(19)
    s_barrier
    ds_read_b64_tr_b16 a[144:145], v83 offset:36864
    ds_read_b64_tr_b16 a[146:147], v83 offset:37632
    buffer_load_dwordx4 v6, s[28:31], s72 offen offset:2048 lds
    s_waitcnt lgkmcnt(6)
    v_mfma_f32_32x32x16_bf16 v[208:223], a[128:131], a[40:43], v[208:223]
    ds_read_b64_tr_b16 a[148:149], v83 offset:36928
    ds_read_b64_tr_b16 a[150:151], v83 offset:37696
    v_mfma_f32_32x32x16_bf16 v[176:191], a[132:135], a[44:47], v[176:191]
    ds_read_b64_tr_b16 a[152:153], v83 offset:36992
    ds_read_b64_tr_b16 a[154:155], v83 offset:37760
    buffer_load_dwordx4 v7, s[28:31], s72 offen offset:3072 lds
    s_waitcnt lgkmcnt(6)
    s_nop 0
    v_mfma_f32_32x32x16_bf16 v[192:207], a[136:139], a[44:47], v[192:207]
    ds_read_b64_tr_b16 a[156:157], v84 offset:36864
    ds_read_b64_tr_b16 a[158:159], v84 offset:37632
    v_mfma_f32_32x32x16_bf16 v[208:223], a[140:143], a[44:47], v[208:223]
    ds_read_b64_tr_b16 a[128:129], v84 offset:36928
    ds_read_b64_tr_b16 a[130:131], v84 offset:37696
    s_add_u32 s6, s6, 128
    s_and_b32 s6, s6, 0x380
    s_mul_i32 s7, s6, 1376
    s_add_u32 m0, s46, 12288
    s_add_u32 s70, s42, s7
    buffer_load_dwordx4 v80, s[16:19], s70 offen offset:0 lds
    s_waitcnt lgkmcnt(6)
    v_mfma_f32_32x32x16_bf16 v[176:191], a[144:147], a[48:51], v[176:191]
    ds_read_b64_tr_b16 a[132:133], v84 offset:36992
    ds_read_b64_tr_b16 a[134:135], v84 offset:37760
    v_mfma_f32_16x16x32_bf16 a[200:203], v[28:31], a[144:147], a[200:203]
    v_mfma_f32_32x32x16_bf16 v[192:207], a[148:151], a[48:51], v[192:207]
    ds_read_b64_tr_b16 a[136:137], v85 offset:36864
    ds_read_b64_tr_b16 a[138:139], v85 offset:37632
    buffer_load_dwordx4 v81, s[16:19], s70 offen offset:1024 lds
    v_mfma_f32_16x16x32_bf16 a[204:207], v[28:31], a[148:151], a[204:207]
    s_waitcnt lgkmcnt(6)
    v_mfma_f32_32x32x16_bf16 v[208:223], a[152:155], a[48:51], v[208:223]
    ds_read_b64_tr_b16 a[140:141], v85 offset:36928
    ds_read_b64_tr_b16 a[142:143], v85 offset:37696
    v_mfma_f32_16x16x32_bf16 a[208:211], v[28:31], a[152:155], a[208:211]
    buffer_load_dwordx4 v82, s[16:19], s70 offen offset:2048 lds
    v_mfma_f32_32x32x16_bf16 v[176:191], a[156:159], a[52:55], v[176:191]
    ds_read_b64_tr_b16 a[144:145], v85 offset:36992
    ds_read_b64_tr_b16 a[146:147], v85 offset:37760
    s_waitcnt lgkmcnt(6)
    v_mfma_f32_32x32x16_bf16 v[192:207], a[128:131], a[52:55], v[192:207]
    ds_read_b64_tr_b16 a[148:149], v86 offset:36864
    ds_read_b64_tr_b16 a[150:151], v86 offset:37632
    v_mfma_f32_32x32x16_bf16 v[208:223], a[132:135], a[52:55], v[208:223]
    ds_read_b64_tr_b16 a[152:153], v86 offset:36928
    ds_read_b64_tr_b16 a[154:155], v86 offset:37696
    s_bfe_u32 s75, s40, 0x20002
    s_lshl_b32 s70, s75, 13
    s_add_u32 m0, s70, s45
    s_add_u32 s70, s61, 49152
    buffer_load_dwordx4 v136, s[32:35], s70 offen offset:0 lds
    s_waitcnt lgkmcnt(6)
    v_mfma_f32_32x32x16_bf16 v[176:191], a[136:139], a[56:59], v[176:191]
    ds_read_b64_tr_b16 a[156:157], v86 offset:36992
    ds_read_b64_tr_b16 a[158:159], v86 offset:37760
    v_mfma_f32_32x32x16_bf16 v[192:207], a[140:143], a[56:59], v[192:207]
    s_waitcnt vmcnt(8)
    s_barrier
    ds_read_b64_tr_b16 a[128:129], v83 offset:0
    ds_read_b64_tr_b16 a[130:131], v83 offset:768
    s_bfe_u32 s75, s40, 0x20002
    s_and_b32 s70, s75, 2
    s_lshl1_add_u32 s70, s70, s75
    s_lshl_b32 s70, s70, 14
    s_add_u32 s70, s70, s95
    buffer_load_dwordx4 v137, s[32:35], s70 offen offset:1024 lds
    s_waitcnt lgkmcnt(6)
    v_mfma_f32_32x32x16_bf16 v[208:223], a[144:147], a[56:59], v[208:223]
    ds_read_b64_tr_b16 a[132:133], v83 offset:64
    ds_read_b64_tr_b16 a[134:135], v83 offset:832
    v_mfma_f32_32x32x16_bf16 v[176:191], a[148:151], a[60:63], v[176:191]
    ds_read_b64_tr_b16 a[136:137], v83 offset:128
    ds_read_b64_tr_b16 a[138:139], v83 offset:896
    buffer_load_dwordx4 v[144:147], v9, s[84:87], s94 offen offset:0 sc1
    buffer_load_dwordx4 v[148:151], v9, s[84:87], s94 offen offset:1024 sc1
    s_add_u32 s6, s6, 128
    s_and_b32 s6, s6, 0x380
    s_mul_i32 s7, s6, 1376
    s_add_u32 m0, s46, 24576
    s_add_u32 s70, s42, s7
    buffer_load_dwordx4 v80, s[16:19], s70 offen offset:0 lds
    s_waitcnt lgkmcnt(6)
    v_mfma_f32_32x32x16_bf16 v[192:207], a[152:155], a[60:63], v[192:207]
    ds_read_b64_tr_b16 a[140:141], v84 offset:0
    ds_read_b64_tr_b16 a[142:143], v84 offset:768
    v_mfma_f32_32x32x16_bf16 v[208:223], a[156:159], a[60:63], v[208:223]
    ds_read_b64_tr_b16 a[144:145], v84 offset:64
    ds_read_b64_tr_b16 a[146:147], v84 offset:832
    s_waitcnt lgkmcnt(6)
    v_mfma_f32_32x32x16_bf16 v[176:191], a[128:131], a[64:67], v[176:191]
    ds_read_b64_tr_b16 a[148:149], v84 offset:128
    ds_read_b64_tr_b16 a[150:151], v84 offset:896
    buffer_load_dwordx4 v81, s[16:19], s70 offen offset:1024 lds
    v_mfma_f32_16x16x32_bf16 a[200:203], v[28:31], a[128:131], a[200:203]
    v_mfma_f32_32x32x16_bf16 v[192:207], a[132:135], a[64:67], v[192:207]
    ds_read_b64_tr_b16 a[152:153], v85 offset:0
    ds_read_b64_tr_b16 a[154:155], v85 offset:768
    v_mfma_f32_16x16x32_bf16 a[204:207], v[28:31], a[132:135], a[204:207]
    buffer_load_dwordx4 v82, s[16:19], s70 offen offset:2048 lds
    s_waitcnt lgkmcnt(6)
    v_mfma_f32_32x32x16_bf16 v[208:223], a[136:139], a[64:67], v[208:223]
    ds_read_b64_tr_b16 a[156:157], v85 offset:64
    ds_read_b64_tr_b16 a[158:159], v85 offset:832
    v_mfma_f32_16x16x32_bf16 a[208:211], v[28:31], a[136:139], a[208:211]
    v_mfma_f32_32x32x16_bf16 v[176:191], a[140:143], a[68:71], v[176:191]
    ds_read_b64_tr_b16 a[128:129], v85 offset:128
    ds_read_b64_tr_b16 a[130:131], v85 offset:896
    s_bfe_u32 s75, s40, 0x20004
    s_lshl_b32 s70, s75, 13
    s_add_u32 m0, s70, s45
    s_add_u32 s70, s62, 49152
    buffer_load_dwordx4 v136, s[32:35], s70 offen offset:0 lds
    s_waitcnt lgkmcnt(6)
    v_mfma_f32_32x32x16_bf16 v[192:207], a[144:147], a[68:71], v[192:207]
    ds_read_b64_tr_b16 a[132:133], v86 offset:0
    ds_read_b64_tr_b16 a[134:135], v86 offset:768
    v_mfma_f32_32x32x16_bf16 v[208:223], a[148:151], a[68:71], v[208:223]
    ds_read_b64_tr_b16 a[136:137], v86 offset:64
    ds_read_b64_tr_b16 a[138:139], v86 offset:832
    s_bfe_u32 s75, s40, 0x20004
    s_and_b32 s70, s75, 2
    s_lshl1_add_u32 s70, s70, s75
    s_lshl_b32 s70, s70, 14
    s_add_u32 s70, s70, s95
    buffer_load_dwordx4 v137, s[32:35], s70 offen offset:1024 lds
    s_waitcnt lgkmcnt(6)
    v_mfma_f32_32x32x16_bf16 v[176:191], a[152:155], a[72:75], v[176:191]
    ds_read_b64_tr_b16 a[140:141], v86 offset:128
    ds_read_b64_tr_b16 a[142:143], v86 offset:896
    v_mfma_f32_32x32x16_bf16 v[192:207], a[156:159], a[72:75], v[192:207]
    s_waitcnt vmcnt(9)
    s_barrier
    ds_read_b64_tr_b16 a[144:145], v83 offset:12288
    ds_read_b64_tr_b16 a[146:147], v83 offset:13056
    s_waitcnt vmcnt(6)
    v_cmp_eq_u64_e64 s[88:89], v[146:147], s[52:53]
    s_waitcnt vmcnt(5)
    v_cmp_eq_u64_e64 s[92:93], v[150:151], s[52:53]
    v_cndmask_b32_e64 v2, 0, 1, s[88:89]
    s_nop 0
    v_addc_co_u32_e64 v2, s[92:93], 0, v2, s[92:93]
    s_waitcnt lgkmcnt(6)
    v_mfma_f32_32x32x16_bf16 v[208:223], a[128:131], a[72:75], v[208:223]
    ds_read_b64_tr_b16 a[148:149], v83 offset:12352
    ds_read_b64_tr_b16 a[150:151], v83 offset:13120
    s_add_u32 s6, s6, 128
    s_and_b32 s6, s6, 0x380
    s_mul_i32 s7, s6, 1376
    s_add_u32 m0, s46, 36864
    s_add_u32 s70, s42, s7
    buffer_load_dwordx4 v80, s[16:19], s70 offen offset:0 lds
    v_cmp_ne_u32_e64 s[88:89], v2, v22
    s_nop 1
    s_cmp_lg_u64 s[88:89], 0
    s_cbranch_scc1 L_slow_car
L_ok_car:
    v_mfma_f32_32x32x16_bf16 v[176:191], a[132:135], a[76:79], v[176:191]
    ds_read_b64_tr_b16 a[152:153], v83 offset:12416
    ds_read_b64_tr_b16 a[154:155], v83 offset:13184
    v_fma_f32 v144, v148, v40, v144
    v_fma_f32 v145, v149, v40, v145
    v_fma_f32 v144, -v149, v41, v144
    v_fma_f32 v145, v148, v41, v145
    s_waitcnt lgkmcnt(6)
    v_mfma_f32_32x32x16_bf16 v[192:207], a[136:139], a[76:79], v[192:207]
    ds_read_b64_tr_b16 a[156:157], v84 offset:12288
    ds_read_b64_tr_b16 a[158:159], v84 offset:13056
    v_mul_f32 v146, v144, v38
    v_mul_f32 v147, v145, v38
    v_fma_f32 v146, -v145, v39, v146
    v_fma_f32 v147, v144, v39, v147
    v_mfma_f32_32x32x16_bf16 v[208:223], a[140:143], a[76:79], v[208:223]
    ds_read_b64_tr_b16 a[128:129], v84 offset:12352
    ds_read_b64_tr_b16 a[130:131], v84 offset:13120
    buffer_load_dwordx4 v81, s[16:19], s70 offen offset:1024 lds
    ds_write_b64 v19, v[146:147] offset:1792
    s_waitcnt lgkmcnt(7)
    v_mfma_f32_32x32x16_bf16 v[176:191], a[144:147], a[80:83], v[176:191]
    ds_read_b64_tr_b16 a[132:133], v84 offset:12416
    ds_read_b64_tr_b16 a[134:135], v84 offset:13184
    v_mfma_f32_16x16x32_bf16 a[200:203], v[28:31], a[144:147], a[200:203]
    v_mfma_f32_32x32x16_bf16 v[192:207], a[148:151], a[80:83], v[192:207]
    buffer_load_dwordx4 v82, s[16:19], s70 offen offset:2048 lds
    s_waitcnt lgkmcnt(2)
    s_barrier
    ds_read_b64_tr_b16 a[136:137], v85 offset:12288
    ds_read_b64_tr_b16 a[138:139], v85 offset:13056
    ds_read_b64 v[144:145], v21 offset:0
    ds_read_b64 v[146:147], v21 offset:256
    v_mfma_f32_16x16x32_bf16 a[204:207], v[28:31], a[148:151], a[204:207]
    ds_read_b64 v[148:149], v21 offset:512
    ds_read_b64 v[150:151], v21 offset:768
    ds_read_b64 v[152:153], v21 offset:1024
    ds_read_b64 v[154:155], v21 offset:1280
    v_mfma_f32_32x32x16_bf16 v[208:223], a[152:155], a[80:83], v[208:223]
    ds_read_b64_tr_b16 a[140:141], v85 offset:12352
    ds_read_b64_tr_b16 a[142:143], v85 offset:13120
    ds_read_b64 v[156:157], v21 offset:1536
    ds_read_b64 v[158:159], v21 offset:1792
    v_mfma_f32_16x16x32_bf16 a[208:211], v[28:31], a[152:155], a[208:211]
    s_bfe_u32 s75, s40, 0x20006
    s_lshl_b32 s70, s75, 13
    s_add_u32 m0, s70, s45
    s_add_u32 s70, s63, 49152
    buffer_load_dwordx4 v136, s[32:35], s70 offen offset:0 lds
    v_mfma_f32_32x32x16_bf16 v[176:191], a[156:159], a[84:87], v[176:191]
    ds_read_b64_tr_b16 a[144:145], v85 offset:12416
    ds_read_b64_tr_b16 a[146:147], v85 offset:13184
    s_waitcnt lgkmcnt(14)
    v_mfma_f32_32x32x16_bf16 v[192:207], a[128:131], a[84:87], v[192:207]
    ds_read_b64_tr_b16 a[148:149], v86 offset:12288
    ds_read_b64_tr_b16 a[150:151], v86 offset:13056
    s_bfe_u32 s75, s40, 0x20006
    s_and_b32 s70, s75, 2
    s_lshl1_add_u32 s70, s70, s75
    s_lshl_b32 s70, s70, 14
    s_add_u32 s70, s70, s95
    buffer_load_dwordx4 v137, s[32:35], s70 offen offset:1024 lds
    s_waitcnt lgkmcnt(12)
    v_add_f32 v144, v144, v146
    v_add_f32 v145, v145, v147
    s_waitcnt lgkmcnt(10)
    v_add_f32 v148, v148, v150
    v_add_f32 v149, v149, v151
    v_mfma_f32_32x32x16_bf16 v[208:223], a[132:135], a[84:87], v[208:223]
    ds_read_b64_tr_b16 a[152:153], v86 offset:12352
    ds_read_b64_tr_b16 a[154:155], v86 offset:13120
    s_waitcnt lgkmcnt(10)
    v_add_f32 v152, v152, v154
    v_add_f32 v153, v153, v155
    s_waitcnt lgkmcnt(6)
    v_add_f32 v156, v156, v158
    v_add_f32 v157, v157, v159
    v_mfma_f32_32x32x16_bf16 v[176:191], a[136:139], a[88:91], v[176:191]
    ds_read_b64_tr_b16 a[156:157], v86 offset:12416
    ds_read_b64_tr_b16 a[158:159], v86 offset:13184
    v_add_f32 v144, v144, v148
    v_add_f32 v145, v145, v149
    v_add_f32 v152, v152, v156
    v_add_f32 v153, v153, v157
    v_mfma_f32_32x32x16_bf16 v[192:207], a[140:143], a[88:91], v[192:207]
    s_waitcnt vmcnt(7)
    s_barrier
    ds_read_b64_tr_b16 a[128:129], v83 offset:24576
    ds_read_b64_tr_b16 a[130:131], v83 offset:25344
    v_add_f32 v144, v144, v152
    v_add_f32 v145, v145, v153
    v_fma_f32 v132, v144, v42, v132
    v_fma_f32 v133, v145, v42, v133
    s_waitcnt lgkmcnt(6)
    v_mfma_f32_32x32x16_bf16 v[208:223], a[144:147], a[88:91], v[208:223]
    ds_read_b64_tr_b16 a[132:133], v83 offset:24640
    ds_read_b64_tr_b16 a[134:135], v83 offset:25408
    s_add_u32 m0, s46, 0
    s_mov_b32 s70, s60
    buffer_load_dwordx4 v136, s[32:35], s70 offen offset:0 lds
    v_fma_f32 v132, -v145, v43, v132
    v_fma_f32 v133, v144, v43, v133
    v_mfma_f32_32x32x16_bf16 v[176:191], a[148:151], a[92:95], v[176:191]
    ds_read_b64_tr_b16 a[136:137], v83 offset:24704
    ds_read_b64_tr_b16 a[138:139], v83 offset:25472
    v_pk_fma_f32 v[48:49], v[132:133], v[32:33], v[48:49] op_sel_hi:[1,0,1]
    v_pk_fma_f32 v[48:49], v[132:133], v[32:33], v[48:49] op_sel:[1,1,0] op_sel_hi:[0,1,1] neg_lo:[0,1,0]
    v_pk_fma_f32 v[50:51], v[48:49], v[32:33], v[50:51] op_sel_hi:[1,0,1]
    v_pk_fma_f32 v[50:51], v[48:49], v[32:33], v[50:51] op_sel:[1,1,0] op_sel_hi:[0,1,1] neg_lo:[0,1,0]
    v_cvt_pk_bf16_f32 v144, v48, v50
    v_cvt_pk_bf16_f32 v152, v49, v51
    v_pk_fma_f32 v[52:53], v[50:51], v[32:33], v[52:53] op_sel_hi:[1,0,1]
    v_pk_fma_f32 v[52:53], v[50:51], v[32:33], v[52:53] op_sel:[1,1,0] op_sel_hi:[0,1,1] neg_lo:[0,1,0]
    v_pk_fma_f32 v[54:55], v[52:53], v[32:33], v[54:55] op_sel_hi:[1,0,1]
    v_pk_fma_f32 v[54:55], v[52:53], v[32:33], v[54:55] op_sel:[1,1,0] op_sel_hi:[0,1,1] neg_lo:[0,1,0]
    v_cvt_pk_bf16_f32 v145, v52, v54
    v_cvt_pk_bf16_f32 v153, v53, v55
    v_pk_fma_f32 v[56:57], v[54:55], v[32:33], v[56:57] op_sel_hi:[1,0,1]
    v_pk_fma_f32 v[56:57], v[54:55], v[32:33], v[56:57] op_sel:[1,1,0] op_sel_hi:[0,1,1] neg_lo:[0,1,0]
    v_pk_fma_f32 v[58:59], v[56:57], v[32:33], v[58:59] op_sel_hi:[1,0,1]
    v_pk_fma_f32 v[58:59], v[56:57], v[32:33], v[58:59] op_sel:[1,1,0] op_sel_hi:[0,1,1] neg_lo:[0,1,0]
    v_cvt_pk_bf16_f32 v146, v56, v58
    v_cvt_pk_bf16_f32 v154, v57, v59
    v_pk_fma_f32 v[60:61], v[58:59], v[32:33], v[60:61] op_sel_hi:[1,0,1]
    v_pk_fma_f32 v[60:61], v[58:59], v[32:33], v[60:61] op_sel:[1,1,0] op_sel_hi:[0,1,1] neg_lo:[0,1,0]
    v_pk_fma_f32 v[62:63], v[60:61], v[32:33], v[62:63] op_sel_hi:[1,0,1]
    v_pk_fma_f32 v[62:63], v[60:61], v[32:33], v[62:63] op_sel:[1,1,0] op_sel_hi:[0,1,1] neg_lo:[0,1,0]
    v_cvt_pk_bf16_f32 v147, v60, v62
    v_cvt_pk_bf16_f32 v155, v61, v63
    v_pk_fma_f32 v[64:65], v[62:63], v[32:33], v[64:65] op_sel_hi:[1,0,1]
    v_pk_fma_f32 v[64:65], v[62:63], v[32:33], v[64:65] op_sel:[1,1,0] op_sel_hi:[0,1,1] neg_lo:[0,1,0]
    ds_write_b128 v11, v[144:147] offset:0
    v_pk_fma_f32 v[66:67], v[64:65], v[32:33], v[66:67] op_sel_hi:[1,0,1]
    v_pk_fma_f32 v[66:67], v[64:65], v[32:33], v[66:67] op_sel:[1,1,0] op_sel_hi:[0,1,1] neg_lo:[0,1,0]
    v_cvt_pk_bf16_f32 v148, v64, v66
    v_cvt_pk_bf16_f32 v156, v65, v67
    v_pk_fma_f32 v[68:69], v[66:67], v[32:33], v[68:69] op_sel_hi:[1,0,1]
    v_pk_fma_f32 v[68:69], v[66:67], v[32:33], v[68:69] op_sel:[1,1,0] op_sel_hi:[0,1,1] neg_lo:[0,1,0]
    ds_write_b128 v11, v[152:155] offset:2048
    v_pk_fma_f32 v[70:71], v[68:69], v[32:33], v[70:71] op_sel_hi:[1,0,1]
    v_pk_fma_f32 v[70:71], v[68:69], v[32:33], v[70:71] op_sel:[1,1,0] op_sel_hi:[0,1,1] neg_lo:[0,1,0]
    v_cvt_pk_bf16_f32 v149, v68, v70
    v_cvt_pk_bf16_f32 v157, v69, v71
    v_pk_fma_f32 v[72:73], v[70:71], v[32:33], v[72:73] op_sel_hi:[1,0,1]
    v_pk_fma_f32 v[72:73], v[70:71], v[32:33], v[72:73] op_sel:[1,1,0] op_sel_hi:[0,1,1] neg_lo:[0,1,0]
    v_pk_fma_f32 v[74:75], v[72:73], v[32:33], v[74:75] op_sel_hi:[1,0,1]
    v_pk_fma_f32 v[74:75], v[72:73], v[32:33], v[74:75] op_sel:[1,1,0] op_sel_hi:[0,1,1] neg_lo:[0,1,0]
    v_cvt_pk_bf16_f32 v150, v72, v74
    v_cvt_pk_bf16_f32 v158, v73, v75
    v_pk_fma_f32 v[76:77], v[74:75], v[32:33], v[76:77] op_sel_hi:[1,0,1]
    v_pk_fma_f32 v[76:77], v[74:75], v[32:33], v[76:77] op_sel:[1,1,0] op_sel_hi:[0,1,1] neg_lo:[0,1,0]
    v_pk_fma_f32 v[78:79], v[76:77], v[32:33], v[78:79] op_sel_hi:[1,0,1]
    v_pk_fma_f32 v[78:79], v[76:77], v[32:33], v[78:79] op_sel:[1,1,0] op_sel_hi:[0,1,1] neg_lo:[0,1,0]
    v_cvt_pk_bf16_f32 v151, v76, v78
    v_cvt_pk_bf16_f32 v159, v77, v79
    s_waitcnt lgkmcnt(8)
    s_nop 0
    v_mfma_f32_32x32x16_bf16 v[192:207], a[152:155], a[92:95], v[192:207]
    ds_read_b64_tr_b16 a[140:141], v84 offset:24576
    ds_read_b64_tr_b16 a[142:143], v84 offset:25344
    buffer_load_dwordx4 v137, s[32:35], s70 offen offset:1024 lds
    ds_write_b128 v10, v[148:151] offset:0
    ds_write_b128 v10, v[156:159] offset:2048
    v_mfma_f32_32x32x16_bf16 v[208:223], a[156:159], a[92:95], v[208:223]
    ds_read_b64_tr_b16 a[144:145], v84 offset:24640
    ds_read_b64_tr_b16 a[146:147], v84 offset:25408
    ds_read_b64_tr_b16 a[160:161], v12 offset:0
    ds_read_b64_tr_b16 a[162:163], v12 offset:256
    ds_read_b64_tr_b16 a[164:165], v0 offset:1024
    s_waitcnt lgkmcnt(13)
    s_nop 0
    v_mfma_f32_32x32x16_bf16 v[176:191], a[128:131], a[96:99], v[176:191]
    ds_read_b64_tr_b16 a[148:149], v84 offset:24704
    ds_read_b64_tr_b16 a[150:151], v84 offset:25472
    buffer_load_dwordx4 v138, s[32:35], s70 offen offset:2048 lds
    ds_read_b64_tr_b16 a[166:167], v0 offset:1280
    ds_read_b64_tr_b16 a[168:169], v12 offset:2048
    v_mfma_f32_16x16x32_bf16 a[200:203], v[28:31], a[128:131], a[200:203]
    ds_read_b64_tr_b16 a[170:171], v12 offset:2304
    ds_read_b64_tr_b16 a[172:173], v0 offset:3072
    v_mfma_f32_32x32x16_bf16 v[192:207], a[132:135], a[96:99], v[192:207]
    ds_read_b64_tr_b16 a[152:153], v85 offset:24576
    ds_read_b64_tr_b16 a[154:155], v85 offset:25344
    ds_read_b64_tr_b16 a[174:175], v0 offset:3328
    v_mfma_f32_16x16x32_bf16 a[204:207], v[28:31], a[132:135], a[204:207]
    s_waitcnt lgkmcnt(15)
    v_mfma_f32_32x32x16_bf16 v[208:223], a[136:139], a[96:99], v[208:223]
    ds_read_b64_tr_b16 a[156:157], v85 offset:24640
    ds_read_b64_tr_b16 a[158:159], v85 offset:25408
    s_waitcnt lgkmcnt(12)
    buffer_store_dwordx4 a[160:163], v25, s[20:23], s15 offen offset:0 sc1
    v_mfma_f32_16x16x32_bf16 a[208:211], v[28:31], a[136:139], a[208:211]
    v_mfma_f32_32x32x16_bf16 v[176:191], a[140:143], a[100:103], v[176:191]
    ds_read_b64_tr_b16 a[128:129], v85 offset:24704
    ds_read_b64_tr_b16 a[130:131], v85 offset:25472
    s_waitcnt lgkmcnt(10)
    buffer_store_dwordx4 a[164:167], v25, s[20:23], s15 offen offset:1024 sc1
    v_mfma_f32_32x32x16_bf16 v[192:207], a[144:147], a[100:103], v[192:207]
    ds_read_b64_tr_b16 a[132:133], v86 offset:24576
    ds_read_b64_tr_b16 a[134:135], v86 offset:25344
    v_mfma_f32_32x32x16_bf16 v[208:223], a[148:151], a[100:103], v[208:223]
    ds_read_b64_tr_b16 a[136:137], v86 offset:24640
    ds_read_b64_tr_b16 a[138:139], v86 offset:25408
    s_waitcnt lgkmcnt(12)
    buffer_store_dwordx4 a[168:171], v25, s[20:23], s41 offen offset:0 sc1
    s_waitcnt lgkmcnt(6)
    v_mfma_f32_32x32x16_bf16 v[176:191], a[152:155], a[104:107], v[176:191]
    ds_read_b64_tr_b16 a[140:141], v86 offset:24704
    ds_read_b64_tr_b16 a[142:143], v86 offset:25472
    v_mfma_f32_32x32x16_bf16 v[192:207], a[156:159], a[104:107], v[192:207]
    s_waitcnt vmcnt(8)
    s_barrier
    ds_read_b64_tr_b16 a[144:145], v83 offset:36864
    ds_read_b64_tr_b16 a[146:147], v83 offset:37632
    s_waitcnt lgkmcnt(6)
    v_mfma_f32_32x32x16_bf16 v[208:223], a[128:131], a[104:107], v[208:223]
    ds_read_b64_tr_b16 a[148:149], v83 offset:36928
    ds_read_b64_tr_b16 a[150:151], v83 offset:37696
    s_add_u32 m0, s46, 12288
    s_mov_b32 s70, s61
    buffer_load_dwordx4 v136, s[32:35], s70 offen offset:0 lds
    v_mfma_f32_32x32x16_bf16 v[176:191], a[132:135], a[108:111], v[176:191]
    ds_read_b64_tr_b16 a[152:153], v83 offset:36992
    ds_read_b64_tr_b16 a[154:155], v83 offset:37760
    buffer_store_dwordx4 a[172:175], v25, s[20:23], s41 offen offset:1024 sc1
    s_waitcnt lgkmcnt(6)
    v_mfma_f32_32x32x16_bf16 v[192:207], a[136:139], a[108:111], v[192:207]
    ds_read_b64_tr_b16 a[156:157], v84 offset:36864
    ds_read_b64_tr_b16 a[158:159], v84 offset:37632
    buffer_load_dwordx4 v137, s[32:35], s70 offen offset:1024 lds
    v_mfma_f32_32x32x16_bf16 v[208:223], a[140:143], a[108:111], v[208:223]
    ds_read_b64_tr_b16 a[128:129], v84 offset:36928
    ds_read_b64_tr_b16 a[130:131], v84 offset:37696
    s_waitcnt lgkmcnt(6)
    v_mfma_f32_32x32x16_bf16 v[176:191], a[144:147], a[112:115], v[176:191]
    ds_read_b64_tr_b16 a[132:133], v84 offset:36992
    ds_read_b64_tr_b16 a[134:135], v84 offset:37760
    buffer_load_dwordx4 v138, s[32:35], s70 offen offset:2048 lds
    v_mfma_f32_16x16x32_bf16 a[200:203], v[28:31], a[144:147], a[200:203]
    v_mfma_f32_32x32x16_bf16 v[192:207], a[148:151], a[112:115], v[192:207]
    ds_read_b64_tr_b16 a[136:137], v85 offset:36864
    ds_read_b64_tr_b16 a[138:139], v85 offset:37632
    v_mfma_f32_16x16x32_bf16 a[204:207], v[28:31], a[148:151], a[204:207]
    s_waitcnt lgkmcnt(6)
    v_mfma_f32_32x32x16_bf16 v[208:223], a[152:155], a[112:115], v[208:223]
    ds_read_b64_tr_b16 a[140:141], v85 offset:36928
    ds_read_b64_tr_b16 a[142:143], v85 offset:37696
    v_mfma_f32_16x16x32_bf16 a[208:211], v[28:31], a[152:155], a[208:211]
    v_mfma_f32_32x32x16_bf16 v[176:191], a[156:159], a[116:119], v[176:191]
    ds_read_b64_tr_b16 a[144:145], v85 offset:36992
    ds_read_b64_tr_b16 a[146:147], v85 offset:37760
    ds_write_b32 v139, a200 offset:1024
    ds_write_b32 v139, a204 offset:1536
    s_nop 2
    ds_write_b32 v139, a208 offset:2048
    s_waitcnt lgkmcnt(9)
    v_mfma_f32_32x32x16_bf16 v[192:207], a[128:131], a[116:119], v[192:207]
    ds_read_b64_tr_b16 a[148:149], v86 offset:36864
    ds_read_b64_tr_b16 a[150:151], v86 offset:37632
    v_mfma_f32_32x32x16_bf16 v[208:223], a[132:135], a[116:119], v[208:223]
    ds_read_b64_tr_b16 a[152:153], v86 offset:36928
    ds_read_b64_tr_b16 a[154:155], v86 offset:37696
    s_waitcnt lgkmcnt(9)
    v_mfma_f32_32x32x16_bf16 v[176:191], a[136:139], a[120:123], v[176:191]
    s_waitcnt lgkmcnt(4)
    s_barrier
    ds_read_b64_tr_b16 a[156:157], v86 offset:36992
    ds_read_b64_tr_b16 a[158:159], v86 offset:37760
    v_mfma_f32_32x32x16_bf16 v[192:207], a[140:143], a[120:123], v[192:207]
    ds_read_b64 v[90:91], v87 offset:1024
    ds_read_b64 v[92:93], v87 offset:1536
    ds_read_b64 v[94:95], v87 offset:2048
    s_add_u32 m0, s46, 24576
    s_mov_b32 s70, s62
    buffer_load_dwordx4 v136, s[32:35], s70 offen offset:0 lds
    s_waitcnt lgkmcnt(7)
    v_mfma_f32_32x32x16_bf16 v[208:223], a[144:147], a[120:123], v[208:223]
    v_mfma_f32_32x32x16_bf16 v[176:191], a[148:151], a[124:127], v[176:191]
    s_waitcnt lgkmcnt(2)
    v_add_f32 v90, v90, v91
    v_cvt_pk_bf16_f32 v91, v90, v90
    v_lshlrev_b32 v91, 16, v91
    v_sub_f32 v91, v90, v91
    v_cvt_pk_bf16_f32 v232, v90, v91
    buffer_load_dwordx4 v137, s[32:35], s70 offen offset:1024 lds
    v_mfma_f32_32x32x16_bf16 v[192:207], a[152:155], a[124:127], v[192:207]
    v_cvt_pk_bf16_f32 v233, v90, v91
    s_waitcnt lgkmcnt(1)
    v_add_f32 v92, v92, v93
    v_cvt_pk_bf16_f32 v93, v92, v92
    v_lshlrev_b32 v93, 16, v93
    v_sub_f32 v93, v92, v93
    v_cvt_pk_bf16_f32 v236, v92, v93
    v_mfma_f32_32x32x16_bf16 v[208:223], a[156:159], a[124:127], v[208:223]
    v_cvt_pk_bf16_f32 v237, v92, v93
    s_waitcnt lgkmcnt(0)
    v_add_f32 v94, v94, v95
    v_cvt_pk_bf16_f32 v95, v94, v94
    v_lshlrev_b32 v95, 16, v95
    v_sub_f32 v95, v94, v95
    v_cvt_pk_bf16_f32 v240, v94, v95
    buffer_load_dwordx4 v138, s[32:35], s70 offen offset:2048 lds
    v_mfma_f32_32x32x16_bf16 v[176:191], v[232:235], v[244:247], v[176:191]
    v_cvt_pk_bf16_f32 v241, v94, v95
    v_mfma_f32_32x32x16_bf16 v[192:207], v[236:239], v[244:247], v[192:207]
    s_nop 0
    v_mfma_f32_32x32x16_bf16 v[208:223], v[240:243], v[244:247], v[208:223]
    s_barrier
    s_add_u32 m0, s46, 36864
    s_mov_b32 s70, s63
    buffer_load_dwordx4 v136, s[32:35], s70 offen offset:0 lds
    buffer_load_dwordx4 v137, s[32:35], s70 offen offset:1024 lds
    buffer_load_dwordx4 v138, s[32:35], s70 offen offset:2048 lds
    s_xor_b32 m0, s44, 12288
    s_nop 0
    buffer_load_dwordx4 v4, s[28:31], s73 offen offset:0 lds
    buffer_load_dwordx4 v5, s[28:31], s73 offen offset:1024 lds
    buffer_load_dwordx4 v6, s[28:31], s73 offen offset:2048 lds
    buffer_load_dwordx4 v7, s[28:31], s73 offen offset:3072 lds
    s_cmp_lg_u64 s[54:55], 0
    s_cbranch_scc1 L_remote
    s_nop 0
    v_pk_mul_f32 v[80:81], v[176:177], v[176:177]
    v_pk_mul_f32 v[82:83], v[178:179], v[178:179]
    v_pk_mul_f32 v[84:85], v[180:181], v[180:181]
    v_pk_mul_f32 v[86:87], v[182:183], v[182:183]
    v_pk_mul_f32 v[88:89], v[184:185], v[184:185]
    v_pk_mul_f32 v[90:91], v[186:187], v[186:187]
    v_pk_mul_f32 v[92:93], v[188:189], v[188:189]
    v_pk_mul_f32 v[94:95], v[190:191], v[190:191]
    v_pk_fma_f32 v[80:81], v[80:81], v[248:249], v[248:249] op_sel:[0,1,0] op_sel_hi:[1,1,0]
    v_pk_fma_f32 v[82:83], v[82:83], v[248:249], v[248:249] op_sel:[0,1,0] op_sel_hi:[1,1,0]
    v_pk_fma_f32 v[84:85], v[84:85], v[248:249], v[248:249] op_sel:[0,1,0] op_sel_hi:[1,1,0]
    v_pk_fma_f32 v[86:87], v[86:87], v[248:249], v[248:249] op_sel:[0,1,0] op_sel_hi:[1,1,0]
    v_pk_fma_f32 v[88:89], v[88:89], v[248:249], v[248:249] op_sel:[0,1,0] op_sel_hi:[1,1,0]
    v_pk_fma_f32 v[90:91], v[90:91], v[248:249], v[248:249] op_sel:[0,1,0] op_sel_hi:[1,1,0]
    v_pk_fma_f32 v[92:93], v[92:93], v[248:249], v[248:249] op_sel:[0,1,0] op_sel_hi:[1,1,0]
    v_pk_fma_f32 v[94:95], v[94:95], v[248:249], v[248:249] op_sel:[0,1,0] op_sel_hi:[1,1,0]
    v_pk_mul_f32 v[80:81], v[80:81], v[176:177]
    v_pk_mul_f32 v[82:83], v[82:83], v[178:179]
    v_pk_mul_f32 v[84:85], v[84:85], v[180:181]
    s_waitcnt vmcnt(12)
    buffer_store_dword v8, v27, s[20:23], s67 offen offset:256
    v_pk_mul_f32 v[86:87], v[86:87], v[182:183]
    v_pk_mul_f32 v[88:89], v[88:89], v[184:185]
    v_pk_mul_f32 v[90:91], v[90:91], v[186:187]
    v_pk_mul_f32 v[92:93], v[92:93], v[188:189]
    v_pk_mul_f32 v[94:95], v[94:95], v[190:191]
    v_exp_f32 v80, v80
    v_exp_f32 v81, v81
    v_exp_f32 v82, v82
    v_exp_f32 v83, v83
    v_exp_f32 v84, v84
    v_exp_f32 v85, v85
    v_exp_f32 v86, v86
    v_exp_f32 v87, v87
    v_exp_f32 v88, v88
    v_exp_f32 v89, v89
    v_exp_f32 v90, v90
    v_exp_f32 v91, v91
    v_exp_f32 v92, v92
    v_exp_f32 v93, v93
    v_exp_f32 v94, v94
    v_exp_f32_e64 v95, v95
    v_pk_fma_f32 v[80:81], v[80:81], v[250:251], v[250:251] op_sel_hi:[1,0,0]
    v_pk_fma_f32 v[82:83], v[82:83], v[250:251], v[250:251] op_sel_hi:[1,0,0]
    v_pk_fma_f32 v[84:85], v[84:85], v[250:251], v[250:251] op_sel_hi:[1,0,0]
    v_pk_fma_f32 v[86:87], v[86:87], v[250:251], v[250:251] op_sel_hi:[1,0,0]
    v_pk_fma_f32 v[88:89], v[88:89], v[250:251], v[250:251] op_sel_hi:[1,0,0]
    v_pk_fma_f32 v[90:91], v[90:91], v[250:251], v[250:251] op_sel_hi:[1,0,0]
    v_pk_fma_f32 v[92:93], v[92:93], v[250:251], v[250:251] op_sel_hi:[1,0,0]
    v_pk_fma_f32 v[94:95], v[94:95], v[250:251], v[250:251] op_sel_hi:[1,0,0]
    v_rcp_f32 v80, v80
    v_rcp_f32 v81, v81
    v_rcp_f32 v82, v82
    v_rcp_f32 v83, v83
    v_rcp_f32 v84, v84
    v_rcp_f32 v85, v85
    v_rcp_f32 v86, v86
    v_rcp_f32 v87, v87
    v_rcp_f32 v88, v88
    v_rcp_f32 v89, v89
    v_rcp_f32 v90, v90
    v_rcp_f32 v91, v91
    v_rcp_f32 v92, v92
    v_rcp_f32 v93, v93
    v_rcp_f32 v94, v94
    v_rcp_f32 v95, v95
    v_pk_mul_f32 v[80:81], v[80:81], v[176:177]
    v_pk_mul_f32 v[82:83], v[82:83], v[178:179]
    v_pk_mul_f32 v[84:85], v[84:85], v[180:181]
    v_pk_mul_f32 v[86:87], v[86:87], v[182:183]
    v_pk_mul_f32 v[88:89], v[88:89], v[184:185]
    v_pk_mul_f32 v[90:91], v[90:91], v[186:187]
    v_pk_mul_f32 v[92:93], v[92:93], v[188:189]
    v_pk_mul_f32 v[94:95], v[94:95], v[190:191]
    v_cvt_pk_bf16_f32 v176, v80, v81
    v_cvt_pk_bf16_f32 v177, v82, v83
    v_cvt_pk_bf16_f32 v178, v84, v85
    v_cvt_pk_bf16_f32 v179, v86, v87
    buffer_store_dwordx4 v[176:179], v25, s[20:23], s64 offen sc1
    v_cvt_pk_bf16_f32 v180, v88, v89
    v_cvt_pk_bf16_f32 v181, v90, v91
    v_cvt_pk_bf16_f32 v182, v92, v93
    v_cvt_pk_bf16_f32 v183, v94, v95
    buffer_store_dwordx4 v[180:183], v25, s[20:23], s64 offen offset:1024 sc1
    v_pk_mul_f32 v[80:81], v[192:193], v[192:193]
    v_pk_mul_f32 v[82:83], v[194:195], v[194:195]
    v_pk_mul_f32 v[84:85], v[196:197], v[196:197]
    v_pk_mul_f32 v[86:87], v[198:199], v[198:199]
    v_pk_mul_f32 v[88:89], v[200:201], v[200:201]
    v_pk_mul_f32 v[90:91], v[202:203], v[202:203]
    v_pk_mul_f32 v[92:93], v[204:205], v[204:205]
    v_pk_mul_f32 v[94:95], v[206:207], v[206:207]
    v_pk_fma_f32 v[80:81], v[80:81], v[248:249], v[248:249] op_sel:[0,1,0] op_sel_hi:[1,1,0]
    v_pk_fma_f32 v[82:83], v[82:83], v[248:249], v[248:249] op_sel:[0,1,0] op_sel_hi:[1,1,0]
    v_pk_fma_f32 v[84:85], v[84:85], v[248:249], v[248:249] op_sel:[0,1,0] op_sel_hi:[1,1,0]
    v_pk_fma_f32 v[86:87], v[86:87], v[248:249], v[248:249] op_sel:[0,1,0] op_sel_hi:[1,1,0]
    v_pk_fma_f32 v[88:89], v[88:89], v[248:249], v[248:249] op_sel:[0,1,0] op_sel_hi:[1,1,0]
    v_pk_fma_f32 v[90:91], v[90:91], v[248:249], v[248:249] op_sel:[0,1,0] op_sel_hi:[1,1,0]
    v_pk_fma_f32 v[92:93], v[92:93], v[248:249], v[248:249] op_sel:[0,1,0] op_sel_hi:[1,1,0]
    v_pk_fma_f32 v[94:95], v[94:95], v[248:249], v[248:249] op_sel:[0,1,0] op_sel_hi:[1,1,0]
    v_pk_mul_f32 v[80:81], v[80:81], v[192:193]
    v_pk_mul_f32 v[82:83], v[82:83], v[194:195]
    v_pk_mul_f32 v[84:85], v[84:85], v[196:197]
    v_pk_mul_f32 v[86:87], v[86:87], v[198:199]
    v_pk_mul_f32 v[88:89], v[88:89], v[200:201]
    v_pk_mul_f32 v[90:91], v[90:91], v[202:203]
    v_pk_mul_f32 v[92:93], v[92:93], v[204:205]
    v_pk_mul_f32 v[94:95], v[94:95], v[206:207]
    v_exp_f32 v80, v80
    v_exp_f32 v81, v81
    v_exp_f32 v82, v82
    v_exp_f32 v83, v83
    v_exp_f32 v84, v84
    v_exp_f32 v85, v85
    v_exp_f32 v86, v86
    v_exp_f32 v87, v87
    v_exp_f32 v88, v88
    v_exp_f32 v89, v89
    v_exp_f32 v90, v90
    v_exp_f32 v91, v91
    v_exp_f32 v92, v92
    v_exp_f32 v93, v93
    v_exp_f32 v94, v94
    v_exp_f32 v95, v95
    v_pk_fma_f32 v[80:81], v[80:81], v[250:251], v[250:251] op_sel_hi:[1,0,0]
    v_pk_fma_f32 v[82:83], v[82:83], v[250:251], v[250:251] op_sel_hi:[1,0,0]
    v_pk_fma_f32 v[84:85], v[84:85], v[250:251], v[250:251] op_sel_hi:[1,0,0]
    v_pk_fma_f32 v[86:87], v[86:87], v[250:251], v[250:251] op_sel_hi:[1,0,0]
    v_pk_fma_f32 v[88:89], v[88:89], v[250:251], v[250:251] op_sel_hi:[1,0,0]
    v_pk_fma_f32 v[90:91], v[90:91], v[250:251], v[250:251] op_sel_hi:[1,0,0]
    v_pk_fma_f32 v[92:93], v[92:93], v[250:251], v[250:251] op_sel_hi:[1,0,0]
    v_pk_fma_f32 v[94:95], v[94:95], v[250:251], v[250:251] op_sel_hi:[1,0,0]
    v_rcp_f32 v80, v80
    v_rcp_f32 v81, v81
    v_rcp_f32 v82, v82
    v_rcp_f32 v83, v83
    v_rcp_f32 v84, v84
    v_rcp_f32 v85, v85
    v_rcp_f32 v86, v86
    v_rcp_f32 v87, v87
    v_rcp_f32 v88, v88
    v_rcp_f32 v89, v89
    v_rcp_f32 v90, v90
    v_rcp_f32 v91, v91
    v_rcp_f32 v92, v92
    v_rcp_f32 v93, v93
    v_rcp_f32 v94, v94
    v_rcp_f32 v95, v95
    v_pk_mul_f32 v[80:81], v[80:81], v[192:193]
    v_pk_mul_f32 v[82:83], v[82:83], v[194:195]
    v_pk_mul_f32 v[84:85], v[84:85], v[196:197]
    v_pk_mul_f32 v[86:87], v[86:87], v[198:199]
    v_pk_mul_f32 v[88:89], v[88:89], v[200:201]
    v_pk_mul_f32 v[90:91], v[90:91], v[202:203]
    v_pk_mul_f32 v[92:93], v[92:93], v[204:205]
    v_pk_mul_f32 v[94:95], v[94:95], v[206:207]
    v_cvt_pk_bf16_f32 v192, v80, v81
    v_cvt_pk_bf16_f32 v193, v82, v83
    v_cvt_pk_bf16_f32 v194, v84, v85
    v_cvt_pk_bf16_f32 v195, v86, v87
    buffer_store_dwordx4 v[192:195], v25, s[20:23], s13 offen sc1
    v_cvt_pk_bf16_f32 v196, v88, v89
    v_cvt_pk_bf16_f32 v197, v90, v91
    v_cvt_pk_bf16_f32 v198, v92, v93
    v_cvt_pk_bf16_f32 v199, v94, v95
    buffer_store_dwordx4 v[196:199], v25, s[20:23], s13 offen offset:1024 sc1
    v_pk_mul_f32 v[80:81], v[208:209], v[208:209]
    v_pk_mul_f32 v[82:83], v[210:211], v[210:211]
    v_pk_mul_f32 v[84:85], v[212:213], v[212:213]
    v_pk_mul_f32 v[86:87], v[214:215], v[214:215]
    v_pk_mul_f32 v[88:89], v[216:217], v[216:217]
    v_pk_mul_f32 v[90:91], v[218:219], v[218:219]
    v_pk_mul_f32 v[92:93], v[220:221], v[220:221]
    v_pk_mul_f32 v[94:95], v[222:223], v[222:223]
    v_pk_fma_f32 v[80:81], v[80:81], v[248:249], v[248:249] op_sel:[0,1,0] op_sel_hi:[1,1,0]
    v_pk_fma_f32 v[82:83], v[82:83], v[248:249], v[248:249] op_sel:[0,1,0] op_sel_hi:[1,1,0]
    v_pk_fma_f32 v[84:85], v[84:85], v[248:249], v[248:249] op_sel:[0,1,0] op_sel_hi:[1,1,0]
    v_pk_fma_f32 v[86:87], v[86:87], v[248:249], v[248:249] op_sel:[0,1,0] op_sel_hi:[1,1,0]
    v_pk_fma_f32 v[88:89], v[88:89], v[248:249], v[248:249] op_sel:[0,1,0] op_sel_hi:[1,1,0]
    v_pk_fma_f32 v[90:91], v[90:91], v[248:249], v[248:249] op_sel:[0,1,0] op_sel_hi:[1,1,0]
    v_pk_fma_f32 v[92:93], v[92:93], v[248:249], v[248:249] op_sel:[0,1,0] op_sel_hi:[1,1,0]
    v_pk_fma_f32 v[94:95], v[94:95], v[248:249], v[248:249] op_sel:[0,1,0] op_sel_hi:[1,1,0]
    v_pk_mul_f32 v[80:81], v[80:81], v[208:209]
    v_pk_mul_f32 v[82:83], v[82:83], v[210:211]
    v_pk_mul_f32 v[84:85], v[84:85], v[212:213]
    v_pk_mul_f32 v[86:87], v[86:87], v[214:215]
    v_pk_mul_f32 v[88:89], v[88:89], v[216:217]
    v_pk_mul_f32 v[90:91], v[90:91], v[218:219]
    v_pk_mul_f32 v[92:93], v[92:93], v[220:221]
    v_pk_mul_f32 v[94:95], v[94:95], v[222:223]
    v_exp_f32 v80, v80
    v_exp_f32 v81, v81
    v_exp_f32 v82, v82
    v_exp_f32 v83, v83
    v_exp_f32 v84, v84
    v_exp_f32 v85, v85
    v_exp_f32 v86, v86
    v_exp_f32 v87, v87
    v_exp_f32 v88, v88
    v_exp_f32 v89, v89
    v_exp_f32 v90, v90
    v_exp_f32 v91, v91
    v_exp_f32 v92, v92
    v_exp_f32 v93, v93
    v_exp_f32 v94, v94
    v_exp_f32 v95, v95
    v_pk_fma_f32 v[80:81], v[80:81], v[250:251], v[250:251] op_sel_hi:[1,0,0]
    v_pk_fma_f32 v[82:83], v[82:83], v[250:251], v[250:251] op_sel_hi:[1,0,0]
    v_pk_fma_f32 v[84:85], v[84:85], v[250:251], v[250:251] op_sel_hi:[1,0,0]
    v_pk_fma_f32 v[86:87], v[86:87], v[250:251], v[250:251] op_sel_hi:[1,0,0]
    v_pk_fma_f32 v[88:89], v[88:89], v[250:251], v[250:251] op_sel_hi:[1,0,0]
    v_pk_fma_f32 v[90:91], v[90:91], v[250:251], v[250:251] op_sel_hi:[1,0,0]
    v_pk_fma_f32 v[92:93], v[92:93], v[250:251], v[250:251] op_sel_hi:[1,0,0]
    v_pk_fma_f32 v[94:95], v[94:95], v[250:251], v[250:251] op_sel_hi:[1,0,0]
    v_rcp_f32 v80, v80
    v_rcp_f32 v81, v81
    v_rcp_f32 v82, v82
    v_rcp_f32 v83, v83
    v_rcp_f32 v84, v84
    v_rcp_f32 v85, v85
    v_rcp_f32 v86, v86
    s_load_dwordx4 s[16:19], s[96:97], s74 offset:256
    v_rcp_f32 v87, v87
    v_rcp_f32 v88, v88
    v_rcp_f32 v89, v89
    v_rcp_f32 v90, v90
    v_rcp_f32 v91, v91
    v_rcp_f32 v92, v92
    v_rcp_f32 v93, v93
    v_rcp_f32 v94, v94
    v_rcp_f32 v95, v95
    v_pk_mul_f32 v[80:81], v[80:81], v[208:209]
    v_pk_mul_f32 v[82:83], v[82:83], v[210:211]
    v_pk_mul_f32 v[84:85], v[84:85], v[212:213]
    v_pk_mul_f32 v[86:87], v[86:87], v[214:215]
    v_pk_mul_f32 v[88:89], v[88:89], v[216:217]
    v_pk_mul_f32 v[90:91], v[90:91], v[218:219]
    v_pk_mul_f32 v[92:93], v[92:93], v[220:221]
    v_pk_mul_f32 v[94:95], v[94:95], v[222:223]
    s_waitcnt vmcnt(2)
    s_nop 0
    buffer_store_dword v8, v27, s[20:23], s67 offen offset:0
    v_cvt_pk_bf16_f32 v208, v80, v81
    v_cvt_pk_bf16_f32 v209, v82, v83
    v_cvt_pk_bf16_f32 v210, v84, v85
    v_cvt_pk_bf16_f32 v211, v86, v87
    buffer_store_dwordx4 v[208:211], v25, s[20:23], s14 offen sc1
    v_cvt_pk_bf16_f32 v212, v88, v89
    v_cvt_pk_bf16_f32 v213, v90, v91
    v_cvt_pk_bf16_f32 v214, v92, v93
    v_cvt_pk_bf16_f32 v215, v94, v95
    buffer_store_dwordx4 v[212:215], v25, s[20:23], s14 offen offset:1024 sc1
    s_barrier
    ds_read_b128 a[128:131], v140 offset:49152
    ds_read_b128 a[132:135], v140 offset:32768
    ds_read_b128 a[136:139], v140 offset:16384
    ds_read_b128 a[140:143], v141 offset:49152
    ds_read_b128 a[144:147], v141 offset:32768
    ds_read_b128 a[148:151], v141 offset:16384
    s_waitcnt lgkmcnt(5)
    v_mfma_f32_32x32x16_bf16 v[80:95], a[160:163], a[128:131], 0
    ds_read_b128 a[152:155], v140 offset:57344
    s_and_b32 s47, s3, 3
    s_lshl_b32 s47, s47, 3
    s_lshr_b32 s47, 0x398db1e4, s47
    ds_read_b128 v[96:99], v251 offset:128
    ds_read_b128 v[100:103], v251 offset:144
    s_waitcnt lgkmcnt(7)
    v_mfma_f32_32x32x16_bf16 v[160:175], a[160:163], a[132:135], 0
    ds_read_b128 a[156:159], v140 offset:40960
    s_bfe_u32 s48, s47, 0x20000
    s_mul_i32 s48, s48, 12288
    v_add_u32 v64, s48, v254
    v_add_u32 v65, s48, v255
    s_waitcnt lgkmcnt(6)
    v_mfma_f32_32x32x16_bf16 v[224:239], a[160:163], a[136:139], 0
    ds_read_b128 a[128:131], v140 offset:24576
    ds_read_b128 v[104:107], v251 offset:160
    ds_read_b128 v[108:111], v251 offset:176
    v_mfma_f32_32x32x16_bf16 v[80:95], a[164:167], a[140:143], v[80:95]
    ds_read_b128 a[132:135], v141 offset:57344
    s_waitcnt lgkmcnt(8)
    v_mfma_f32_32x32x16_bf16 v[160:175], a[164:167], a[144:147], v[160:175]
    ds_read_b128 a[136:139], v141 offset:40960
    s_waitcnt vmcnt(3)
    buffer_store_dword v8, v27, s[20:23], s67 offen offset:64
    v_accvgpr_read_b32 v48, a246
    v_accvgpr_read_b32 v49, a247
    v_mfma_f32_32x32x16_bf16 v[224:239], a[164:167], a[148:151], v[224:239]
    ds_read_b128 a[140:143], v141 offset:24576
    s_waitcnt lgkmcnt(0)
    s_xor_b64 s[16:17], s[16:17], s[78:79]
    s_xor_b64 s[18:19], s[18:19], s[78:79]
    s_or_b64 s[16:17], s[16:17], s[18:19]
    s_cbranch_scc1 L_slow_s3
L_ok_s3:
    buffer_load_dwordx4 a[72:75], v15, s[20:23], s11 offen offset:0 sc1
    v_mfma_f32_32x32x16_bf16 v[80:95], a[168:171], a[152:155], v[80:95]
    ds_read_b64_tr_b16 a[144:145], v65 offset:6144
    ds_read_b64_tr_b16 a[146:147], v65 offset:9216
    buffer_load_dwordx4 a[76:79], v15, s[20:23], s11 offen offset:1024 sc1
    v_lshlrev_b32 v48, 16, v48
    v_lshlrev_b32 v49, 16, v49
    v_mfma_f32_32x32x16_bf16 v[160:175], a[168:171], a[156:159], v[160:175]
    ds_read_b64_tr_b16 a[148:149], v64 offset:6144
    ds_read_b64_tr_b16 a[150:151], v64 offset:9216
    buffer_load_dwordx4 a[80:83], v15, s[20:23], s12 offen offset:0 sc1
    v_mfma_f32_32x32x16_bf16 v[224:239], a[168:171], a[128:131], v[224:239]
    ds_read_b64_tr_b16 a[152:153], v65 offset:0
    ds_read_b64_tr_b16 a[154:155], v65 offset:3072
    v_accvgpr_read_b32 v51, a248
    v_lshlrev_b32 v50, 16, v51
    v_and_b32 v51, 0xffff0000, v51
    v_mfma_f32_32x32x16_bf16 v[80:95], a[172:175], a[132:135], v[80:95]
    ds_read_b64_tr_b16 a[156:157], v65 offset:7168
    ds_read_b64_tr_b16 a[158:159], v65 offset:10240
    buffer_load_dwordx4 a[84:87], v15, s[20:23], s12 offen offset:1024 sc1
    v_mfma_f32_32x32x16_bf16 v[160:175], a[172:175], a[136:139], v[160:175]
    ds_read_b64_tr_b16 a[128:129], v64 offset:7168
    ds_read_b64_tr_b16 a[130:131], v64 offset:10240
    v_fma_f32 v96, v50, v116, -v96
    v_add_f32 v50, v50, v49
    v_fma_f32 v96, v96, v48, v50
    v_mfma_f32_32x32x16_bf16 v[224:239], a[172:175], a[140:143], v[224:239]
    ds_read_b64_tr_b16 a[132:133], v65 offset:1024
    ds_read_b64_tr_b16 a[134:135], v65 offset:4096
    buffer_load_dwordx4 a[88:91], v16, s[20:23], s11 offen offset:0 sc1
    s_waitcnt lgkmcnt(8)
    v_mfma_f32_32x32x16_bf16 v[80:95], v[176:179], a[144:147], v[80:95]
    ds_read_b64_tr_b16 a[136:137], v65 offset:8192
    ds_read_b64_tr_b16 a[138:139], v65 offset:11264
    v_fma_f32 v97, v51, v117, -v97
    v_add_f32 v51, v51, v49
    v_fma_f32 v97, v97, v48, v51
    v_mfma_f32_32x32x16_bf16 v[160:175], v[176:179], a[148:151], v[160:175]
    ds_read_b64_tr_b16 a[140:141], v64 offset:8192
    ds_read_b64_tr_b16 a[142:143], v64 offset:11264
    buffer_load_dwordx4 a[92:95], v16, s[20:23], s11 offen offset:1024 sc1
    s_waitcnt lgkmcnt(8)
    v_mfma_f32_32x32x16_bf16 v[224:239], v[176:179], a[152:155], v[224:239]
    ds_read_b64_tr_b16 a[144:145], v65 offset:2048
    ds_read_b64_tr_b16 a[146:147], v65 offset:5120
    v_accvgpr_read_b32 v51, a249
    v_lshlrev_b32 v50, 16, v51
    v_and_b32 v51, 0xffff0000, v51
    v_mfma_f32_32x32x16_bf16 v[80:95], v[180:183], a[156:159], v[80:95]
    ds_read_b64_tr_b16 a[148:149], v253 offset:4096
    ds_read_b64_tr_b16 a[150:151], v253 offset:6144
    buffer_load_dwordx4 a[96:99], v16, s[20:23], s12 offen offset:0 sc1
    s_waitcnt lgkmcnt(8)
    v_mfma_f32_32x32x16_bf16 v[160:175], v[180:183], a[128:131], v[160:175]
    ds_read_b64_tr_b16 a[152:153], v252 offset:4096
    ds_read_b64_tr_b16 a[154:155], v252 offset:6144
    v_fma_f32 v98, v50, v118, -v98
    v_add_f32 v50, v50, v49
    v_fma_f32 v98, v98, v48, v50
    v_mfma_f32_32x32x16_bf16 v[224:239], v[180:183], a[132:135], v[224:239]
    ds_read_b64_tr_b16 a[156:157], v253 offset:0
    ds_read_b64_tr_b16 a[158:159], v253 offset:2048
    buffer_load_dwordx4 a[100:103], v16, s[20:23], s12 offen offset:1024 sc1
    s_waitcnt lgkmcnt(8)
    v_mfma_f32_32x32x16_bf16 v[80:95], v[192:195], a[136:139], v[80:95]
    ds_read_b128 a[128:131], v142 offset:49152
    v_fma_f32 v99, v51, v119, -v99
    v_add_f32 v51, v51, v49
    v_fma_f32 v99, v99, v48, v51
    v_accvgpr_read_b32 v51, a250
    v_lshlrev_b32 v50, 16, v51
    v_and_b32 v51, 0xffff0000, v51
    v_mfma_f32_32x32x16_bf16 v[160:175], v[192:195], a[140:143], v[160:175]
    ds_read_b128 a[132:135], v142 offset:32768
    buffer_load_dwordx4 a[104:107], v17, s[20:23], s11 offen offset:0 sc1
    v_fma_f32 v100, v50, v120, -v100
    v_add_f32 v50, v50, v49
    v_fma_f32 v100, v100, v48, v50
    s_waitcnt lgkmcnt(6)
    v_mfma_f32_32x32x16_bf16 v[224:239], v[192:195], a[144:147], v[224:239]
    ds_read_b128 a[136:139], v142 offset:16384
    s_waitcnt vmcnt(10)
    buffer_store_dword v8, v27, s[20:23], s67 offen offset:128
    v_fma_f32 v101, v51, v121, -v101
    v_add_f32 v51, v51, v49
    v_fma_f32 v101, v101, v48, v51
    v_mfma_f32_32x32x16_bf16 v[80:95], v[196:199], a[148:151], v[80:95]
    ds_read_b128 a[140:143], v143 offset:49152
    buffer_load_dwordx4 a[108:111], v17, s[20:23], s11 offen offset:1024 sc1
    v_accvgpr_read_b32 v51, a251
    v_lshlrev_b32 v50, 16, v51
    v_and_b32 v51, 0xffff0000, v51
    s_waitcnt lgkmcnt(4)
    v_mfma_f32_32x32x16_bf16 v[160:175], v[196:199], a[152:155], v[160:175]
    ds_read_b128 a[144:147], v143 offset:32768
    v_fma_f32 v102, v50, v122, -v102
    v_add_f32 v50, v50, v49
    v_fma_f32 v102, v102, v48, v50
    v_fma_f32 v103, v51, v123, -v103
    v_add_f32 v51, v51, v49
    v_fma_f32 v103, v103, v48, v51
    v_mfma_f32_32x32x16_bf16 v[224:239], v[196:199], a[156:159], v[224:239]
    ds_read_b128 a[148:151], v143 offset:16384
    buffer_load_dwordx4 a[112:115], v17, s[20:23], s12 offen offset:0 sc1
    v_accvgpr_read_b32 v51, a252
    v_lshlrev_b32 v50, 16, v51
    v_and_b32 v51, 0xffff0000, v51
    s_waitcnt lgkmcnt(4)
    s_waitcnt vmcnt(11)
    v_mfma_f32_32x32x16_bf16 v[80:95], a[72:75], a[128:131], v[80:95]
    ds_read_b128 a[152:155], v142 offset:57344
    v_fma_f32 v104, v50, v124, -v104
    v_add_f32 v50, v50, v49
    v_fma_f32 v104, v104, v48, v50
    v_fma_f32 v105, v51, v125, -v105
    v_add_f32 v51, v51, v49
    v_fma_f32 v105, v105, v48, v51
    v_mfma_f32_32x32x16_bf16 v[160:175], a[72:75], a[132:135], v[160:175]
    ds_read_b128 a[156:159], v142 offset:40960
    buffer_load_dwordx4 a[116:119], v17, s[20:23], s12 offen offset:1024 sc1
    v_accvgpr_read_b32 v51, a253
    v_lshlrev_b32 v50, 16, v51
    v_and_b32 v51, 0xffff0000, v51
    s_waitcnt lgkmcnt(4)
    v_mfma_f32_32x32x16_bf16 v[224:239], a[72:75], a[136:139], v[224:239]
    ds_read_b128 a[128:131], v142 offset:24576
    v_fma_f32 v106, v50, v126, -v106
    v_add_f32 v50, v50, v49
    v_fma_f32 v106, v106, v48, v50
    v_fma_f32 v107, v51, v127, -v107
    v_add_f32 v51, v51, v49
    v_fma_f32 v107, v107, v48, v51
    s_waitcnt vmcnt(11)
    v_mfma_f32_32x32x16_bf16 v[80:95], a[76:79], a[140:143], v[80:95]
    ds_read_b128 a[132:135], v143 offset:57344
    v_accvgpr_read_b32 v51, a254
    v_lshlrev_b32 v50, 16, v51
    v_and_b32 v51, 0xffff0000, v51
    s_waitcnt lgkmcnt(4)
    v_mfma_f32_32x32x16_bf16 v[160:175], a[76:79], a[144:147], v[160:175]
    ds_read_b128 a[136:139], v143 offset:40960
    s_load_dwordx4 s[24:27], s[96:97], s74 offset:0
    s_load_dwordx4 s[28:31], s[96:97], s74 offset:64
    v_fma_f32 v108, v50, v128, -v108
    v_add_f32 v50, v50, v49
    v_fma_f32 v108, v108, v48, v50
    v_mfma_f32_32x32x16_bf16 v[224:239], a[76:79], a[148:151], v[224:239]
    s_barrier
    ds_read_b128 a[140:143], v143 offset:24576
    s_waitcnt lgkmcnt(4)
    s_waitcnt vmcnt(10)
    v_mfma_f32_32x32x16_bf16 v[80:95], a[80:83], a[152:155], v[80:95]
    ds_read_b128 a[144:147], v140 offset:53248
    v_fma_f32 v109, v51, v129, -v109
    v_add_f32 v51, v51, v49
    v_fma_f32 v109, v109, v48, v51
    v_accvgpr_read_b32 v51, a255
    v_lshlrev_b32 v50, 16, v51
    v_and_b32 v51, 0xffff0000, v51
    v_mfma_f32_32x32x16_bf16 v[160:175], a[80:83], a[156:159], v[160:175]
    ds_read_b128 a[148:151], v140 offset:36864
    v_fma_f32 v110, v50, v130, -v110
    v_add_f32 v50, v50, v49
    v_fma_f32 v110, v110, v48, v50
    s_waitcnt lgkmcnt(4)
    v_mfma_f32_32x32x16_bf16 v[224:239], a[80:83], a[128:131], v[224:239]
    ds_read_b128 a[152:155], v140 offset:20480
    v_fma_f32 v111, v51, v131, -v111
    v_add_f32 v51, v51, v49
    v_fma_f32 v111, v111, v48, v51
    s_waitcnt vmcnt(9)
    v_mfma_f32_32x32x16_bf16 v[80:95], a[84:87], a[132:135], v[80:95]
    ds_read_b128 a[156:159], v141 offset:53248
    s_waitcnt lgkmcnt(4)
    v_mfma_f32_32x32x16_bf16 v[160:175], a[84:87], a[136:139], v[160:175]
    ds_read_b128 a[128:131], v141 offset:36864
    v_mfma_f32_32x32x16_bf16 v[224:239], a[84:87], a[140:143], v[224:239]
    ds_read_b128 a[132:135], v141 offset:20480
    s_waitcnt lgkmcnt(4)
    s_waitcnt vmcnt(8)
    v_mfma_f32_32x32x16_bf16 v[80:95], a[88:91], a[144:147], v[80:95]
    ds_read_b128 a[136:139], v140 offset:61440
    v_mfma_f32_32x32x16_bf16 v[160:175], a[88:91], a[148:151], v[160:175]
    ds_read_b128 a[140:143], v140 offset:45056
    s_waitcnt lgkmcnt(4)
    v_mfma_f32_32x32x16_bf16 v[224:239], a[88:91], a[152:155], v[224:239]
    ds_read_b128 a[144:147], v140 offset:28672
    s_waitcnt lgkmcnt(0)
    s_xor_b64 s[24:25], s[24:25], s[78:79]
    s_xor_b64 s[26:27], s[26:27], s[78:79]
    s_xor_b64 s[28:29], s[28:29], s[78:79]
    s_xor_b64 s[30:31], s[30:31], s[78:79]
    s_or_b64 s[24:25], s[24:25], s[26:27]
    s_or_b64 s[24:25], s[24:25], s[28:29]
    s_or_b64 s[24:25], s[24:25], s[30:31]
    s_cbranch_scc1 L_slow_s5
L_ok_s5:
    buffer_load_dwordx4 a[0:3], v15, s[20:23], s77 offen offset:0 sc1
    s_waitcnt vmcnt(8)
    v_mfma_f32_32x32x16_bf16 v[80:95], a[92:95], a[156:159], v[80:95]
    ds_read_b128 a[148:151], v141 offset:61440
    buffer_load_dwordx4 a[4:7], v15, s[20:23], s77 offen offset:1024 sc1
    v_mfma_f32_32x32x16_bf16 v[160:175], a[92:95], a[128:131], v[160:175]
    ds_read_b128 a[152:155], v141 offset:45056
    buffer_load_dwordx4 a[8:11], v16, s[20:23], s77 offen offset:0 sc1
    v_mfma_f32_32x32x16_bf16 v[224:239], a[92:95], a[132:135], v[224:239]
    ds_read_b128 a[156:159], v141 offset:28672
    s_waitcnt vmcnt(9)
    v_mfma_f32_32x32x16_bf16 v[80:95], a[96:99], a[136:139], v[80:95]
    ds_read_b128 a[128:131], v142 offset:53248
    buffer_load_dwordx4 a[12:15], v16, s[20:23], s77 offen offset:1024 sc1
    v_mfma_f32_32x32x16_bf16 v[160:175], a[96:99], a[140:143], v[160:175]
    ds_read_b128 a[132:135], v142 offset:36864
    s_waitcnt lgkmcnt(4)
    v_mfma_f32_32x32x16_bf16 v[224:239], a[96:99], a[144:147], v[224:239]
    ds_read_b128 a[136:139], v142 offset:20480
    buffer_load_dwordx4 a[16:19], v17, s[20:23], s77 offen offset:0 sc1
    s_waitcnt vmcnt(10)
    v_mfma_f32_32x32x16_bf16 v[80:95], a[100:103], a[148:151], v[80:95]
    ds_read_b128 a[140:143], v143 offset:53248
    s_waitcnt lgkmcnt(4)
    v_mfma_f32_32x32x16_bf16 v[160:175], a[100:103], a[152:155], v[160:175]
    ds_read_b128 a[144:147], v143 offset:36864
    buffer_load_dwordx4 a[20:23], v17, s[20:23], s77 offen offset:1024 sc1
    v_mfma_f32_32x32x16_bf16 v[224:239], a[100:103], a[156:159], v[224:239]
    ds_read_b128 a[148:151], v143 offset:20480
    s_waitcnt lgkmcnt(4)
    s_waitcnt vmcnt(10)
    v_mfma_f32_32x32x16_bf16 v[80:95], a[104:107], a[128:131], v[80:95]
    ds_read_b128 a[152:155], v142 offset:61440
    s_waitcnt vmcnt(6)
    buffer_store_dword v8, v27, s[20:23], s67 offen offset:192
    buffer_load_dwordx4 a[24:27], v15, s[20:23], s8 offen offset:0 sc1
    v_mfma_f32_32x32x16_bf16 v[160:175], a[104:107], a[132:135], v[160:175]
    ds_read_b128 a[156:159], v142 offset:45056
    s_bfe_u32 s48, s47, 0x20002
    s_mul_i32 s48, s48, 12288
    v_add_u32 v66, s48, v254
    v_add_u32 v67, s48, v255
    s_waitcnt lgkmcnt(4)
    v_mfma_f32_32x32x16_bf16 v[224:239], a[104:107], a[136:139], v[224:239]
    ds_read_b128 a[128:131], v142 offset:28672
    buffer_load_dwordx4 a[28:31], v15, s[20:23], s8 offen offset:1024 sc1
    s_bfe_u32 s48, s47, 0x20004
    s_mul_i32 s48, s48, 12288
    v_add_u32 v68, s48, v254
    v_add_u32 v69, s48, v255
    v_mfma_f32_32x32x16_bf16 v[80:95], a[108:111], a[140:143], v[80:95]
    ds_read_b128 a[132:135], v143 offset:61440
    s_bfe_u32 s48, s47, 0x20006
    s_mul_i32 s48, s48, 12288
    v_add_u32 v70, s48, v254
    v_add_u32 v71, s48, v255
    s_waitcnt lgkmcnt(4)
    v_mfma_f32_32x32x16_bf16 v[160:175], a[108:111], a[144:147], v[160:175]
    ds_read_b128 a[136:139], v143 offset:45056
    s_load_dwordx4 s[16:19], s[96:97], s74 offset:128
    buffer_load_dwordx4 a[32:35], v16, s[20:23], s8 offen offset:0 sc1
    v_mfma_f32_32x32x16_bf16 v[224:239], a[108:111], a[148:151], v[224:239]
    ds_read_b128 a[140:143], v143 offset:28672
    s_waitcnt lgkmcnt(4)
    v_mfma_f32_32x32x16_bf16 v[80:95], a[112:115], a[152:155], v[80:95]
    ds_read_b64_tr_b16 a[144:145], v67 offset:6144
    ds_read_b64_tr_b16 a[146:147], v67 offset:9216
    buffer_load_dwordx4 a[36:39], v16, s[20:23], s8 offen offset:1024 sc1
    v_mfma_f32_32x32x16_bf16 v[160:175], a[112:115], a[156:159], v[160:175]
    ds_read_b64_tr_b16 a[148:149], v66 offset:6144
    ds_read_b64_tr_b16 a[150:151], v66 offset:9216
    s_waitcnt lgkmcnt(6)
    v_mfma_f32_32x32x16_bf16 v[224:239], a[112:115], a[128:131], v[224:239]
    ds_read_b64_tr_b16 a[152:153], v67 offset:7168
    ds_read_b64_tr_b16 a[154:155], v67 offset:10240
    buffer_load_dwordx4 a[40:43], v17, s[20:23], s8 offen offset:0 sc1
    v_mfma_f32_32x32x16_bf16 v[80:95], a[116:119], a[132:135], v[80:95]
    ds_read_b64_tr_b16 a[156:157], v66 offset:7168
    ds_read_b64_tr_b16 a[158:159], v66 offset:10240
    s_waitcnt lgkmcnt(8)
    v_mfma_f32_32x32x16_bf16 v[160:175], a[116:119], a[136:139], v[160:175]
    ds_read_b64_tr_b16 a[128:129], v69 offset:6144
    ds_read_b64_tr_b16 a[130:131], v69 offset:9216
    buffer_load_dwordx4 a[44:47], v17, s[20:23], s8 offen offset:1024 sc1
    v_mfma_f32_32x32x16_bf16 v[224:239], a[116:119], a[140:143], v[224:239]
    ds_read_b64_tr_b16 a[132:133], v68 offset:6144
    ds_read_b64_tr_b16 a[134:135], v68 offset:9216
    s_waitcnt lgkmcnt(8)
    s_waitcnt vmcnt(12)
    v_mfma_f32_32x32x16_bf16 v[80:95], a[0:3], a[144:147], v[80:95]
    ds_read_b64_tr_b16 a[136:137], v69 offset:7168
    ds_read_b64_tr_b16 a[138:139], v69 offset:10240
    v_mfma_f32_32x32x16_bf16 v[160:175], a[0:3], a[148:151], v[160:175]
    ds_read_b64_tr_b16 a[140:141], v68 offset:7168
    ds_read_b64_tr_b16 a[142:143], v68 offset:10240
    s_waitcnt lgkmcnt(8)
    s_waitcnt vmcnt(11)
    v_mfma_f32_32x32x16_bf16 v[80:95], a[4:7], a[152:155], v[80:95]
    ds_read_b64_tr_b16 a[144:145], v71 offset:6144
    ds_read_b64_tr_b16 a[146:147], v71 offset:9216
    s_waitcnt lgkmcnt(0)
    s_xor_b64 s[16:17], s[16:17], s[78:79]
    s_xor_b64 s[18:19], s[18:19], s[78:79]
    s_or_b64 s[16:17], s[16:17], s[18:19]
    s_cbranch_scc1 L_slow_s2
L_ok_s2:
    buffer_load_dwordx4 a[48:51], v25, s[20:23], s9 offen offset:0 sc1
    v_mfma_f32_32x32x16_bf16 v[160:175], a[4:7], a[156:159], v[160:175]
    ds_read_b64_tr_b16 a[148:149], v70 offset:6144
    ds_read_b64_tr_b16 a[150:151], v70 offset:9216
    buffer_load_dwordx4 a[52:55], v25, s[20:23], s9 offen offset:1024 sc1
    s_waitcnt vmcnt(12)
    v_mfma_f32_32x32x16_bf16 v[80:95], a[8:11], a[128:131], v[80:95]
    ds_read_b64_tr_b16 a[152:153], v71 offset:7168
    ds_read_b64_tr_b16 a[154:155], v71 offset:10240
    v_mfma_f32_32x32x16_bf16 v[160:175], a[8:11], a[132:135], v[160:175]
    ds_read_b64_tr_b16 a[156:157], v70 offset:7168
    ds_read_b64_tr_b16 a[158:159], v70 offset:10240
    buffer_load_dwordx4 a[56:59], v25, s[20:23], s9 offen offset:2048 sc1
    s_waitcnt vmcnt(12)
    v_mfma_f32_32x32x16_bf16 v[80:95], a[12:15], a[136:139], v[80:95]
    ds_read_b64_tr_b16 a[128:129], v67 offset:8192
    ds_read_b64_tr_b16 a[130:131], v67 offset:11264
    v_mfma_f32_32x32x16_bf16 v[160:175], a[12:15], a[140:143], v[160:175]
    ds_read_b64_tr_b16 a[132:133], v66 offset:8192
    ds_read_b64_tr_b16 a[134:135], v66 offset:11264
    buffer_load_dwordx4 a[60:63], v25, s[20:23], s9 offen offset:3072 sc1
    s_waitcnt lgkmcnt(8)
    s_waitcnt vmcnt(12)
    v_mfma_f32_32x32x16_bf16 v[80:95], a[16:19], a[144:147], v[80:95]
    ds_read_b64_tr_b16 a[136:137], v253 offset:12288
    ds_read_b64_tr_b16 a[138:139], v253 offset:14336
    v_mfma_f32_32x32x16_bf16 v[160:175], a[16:19], a[148:151], v[160:175]
    ds_read_b64_tr_b16 a[140:141], v252 offset:12288
    ds_read_b64_tr_b16 a[142:143], v252 offset:14336
    buffer_load_dwordx4 a[64:67], v25, s[20:23], s10 offen offset:0 sc1
    s_waitcnt lgkmcnt(8)
    s_waitcnt vmcnt(12)
    v_mfma_f32_32x32x16_bf16 v[80:95], a[20:23], a[152:155], v[80:95]
    ds_read_b64_tr_b16 a[144:145], v69 offset:8192
    ds_read_b64_tr_b16 a[146:147], v69 offset:11264
    v_mfma_f32_32x32x16_bf16 v[160:175], a[20:23], a[156:159], v[160:175]
    ds_read_b64_tr_b16 a[148:149], v68 offset:8192
    ds_read_b64_tr_b16 a[150:151], v68 offset:11264
    buffer_load_dwordx4 a[68:71], v25, s[20:23], s10 offen offset:1024 sc1
    s_waitcnt lgkmcnt(8)
    s_waitcnt vmcnt(11)
    v_mfma_f32_32x32x16_bf16 v[80:95], a[24:27], a[128:131], v[80:95]
    ds_read_b64_tr_b16 a[152:153], v253 offset:20480
    ds_read_b64_tr_b16 a[154:155], v253 offset:22528
    v_mfma_f32_32x32x16_bf16 v[160:175], a[24:27], a[132:135], v[160:175]
    ds_read_b64_tr_b16 a[156:157], v252 offset:20480
    ds_read_b64_tr_b16 a[158:159], v252 offset:22528
    s_waitcnt lgkmcnt(8)
    s_waitcnt vmcnt(10)
    v_mfma_f32_32x32x16_bf16 v[80:95], a[28:31], a[136:139], v[80:95]
    ds_read_b64_tr_b16 a[128:129], v71 offset:8192
    ds_read_b64_tr_b16 a[130:131], v71 offset:11264
    s_waitcnt vmcnt(6)
    buffer_store_dword v8, v27, s[20:23], s67 offen offset:320
    v_mfma_f32_32x32x16_bf16 v[160:175], a[28:31], a[140:143], v[160:175]
    ds_read_b64_tr_b16 a[132:133], v70 offset:8192
    ds_read_b64_tr_b16 a[134:135], v70 offset:11264
    s_waitcnt lgkmcnt(8)
    v_mfma_f32_32x32x16_bf16 v[80:95], a[32:35], a[144:147], v[80:95]
    ds_read_b64_tr_b16 a[136:137], v253 offset:28672
    ds_read_b64_tr_b16 a[138:139], v253 offset:30720
    v_mfma_f32_32x32x16_bf16 v[160:175], a[32:35], a[148:151], v[160:175]
    ds_read_b64_tr_b16 a[140:141], v252 offset:28672
    ds_read_b64_tr_b16 a[142:143], v252 offset:30720
    s_waitcnt lgkmcnt(8)
    v_mfma_f32_32x32x16_bf16 v[80:95], a[36:39], a[152:155], v[80:95]
    ds_read_b64_tr_b16 a[144:145], v253 offset:5120
    ds_read_b64_tr_b16 a[146:147], v253 offset:7168
    s_load_dwordx4 s[28:31], s[96:97], s74 offset:192
    v_mfma_f32_32x32x16_bf16 v[160:175], a[36:39], a[156:159], v[160:175]
    ds_read_b64_tr_b16 a[148:149], v253 offset:13312
    ds_read_b64_tr_b16 a[150:151], v253 offset:15360
    s_waitcnt lgkmcnt(8)
    v_mfma_f32_32x32x16_bf16 v[80:95], a[40:43], a[128:131], v[80:95]
    ds_read_b64_tr_b16 a[152:153], v253 offset:21504
    ds_read_b64_tr_b16 a[154:155], v253 offset:23552
    v_mfma_f32_32x32x16_bf16 v[160:175], a[40:43], a[132:135], v[160:175]
    ds_read_b64_tr_b16 a[156:157], v253 offset:29696
    ds_read_b64_tr_b16 a[158:159], v253 offset:31744
    s_waitcnt lgkmcnt(8)
    v_mfma_f32_32x32x16_bf16 v[80:95], a[44:47], a[136:139], v[80:95]
    ds_read_b64_tr_b16 a[128:129], v253 offset:36864
    ds_read_b64_tr_b16 a[130:131], v253 offset:38912
    v_mfma_f32_32x32x16_bf16 v[160:175], a[44:47], a[140:143], v[160:175]
    ds_read_b64_tr_b16 a[132:133], v253 offset:37888
    ds_read_b64_tr_b16 a[134:135], v253 offset:39936
    s_waitcnt lgkmcnt(8)
    s_waitcnt vmcnt(6)
    v_mfma_f32_32x32x16_bf16 v[80:95], a[48:51], a[144:147], v[80:95]
    ds_read_b64_tr_b16 a[136:137], v252 offset:5120
    ds_read_b64_tr_b16 a[138:139], v252 offset:7168
    s_waitcnt vmcnt(5)
    v_mfma_f32_32x32x16_bf16 v[80:95], a[52:55], a[148:151], v[80:95]
    ds_read_b64_tr_b16 a[140:141], v252 offset:13312
    ds_read_b64_tr_b16 a[142:143], v252 offset:15360
    s_waitcnt lgkmcnt(8)
    s_waitcnt vmcnt(4)
    v_mfma_f32_32x32x16_bf16 v[80:95], a[56:59], a[152:155], v[80:95]
    ds_read_b64_tr_b16 a[144:145], v252 offset:21504
    ds_read_b64_tr_b16 a[146:147], v252 offset:23552
    s_waitcnt vmcnt(3)
    v_mfma_f32_32x32x16_bf16 v[80:95], a[60:63], a[156:159], v[80:95]
    ds_read_b64_tr_b16 a[148:149], v252 offset:29696
    ds_read_b64_tr_b16 a[150:151], v252 offset:31744
    s_waitcnt lgkmcnt(8)
    s_waitcnt vmcnt(2)
    v_mfma_f32_32x32x16_bf16 v[80:95], a[64:67], a[128:131], v[80:95]
    ds_read_b64_tr_b16 a[152:153], v252 offset:36864
    ds_read_b64_tr_b16 a[154:155], v252 offset:38912
    s_waitcnt lgkmcnt(0)
    s_xor_b64 s[28:29], s[28:29], s[78:79]
    s_xor_b64 s[30:31], s[30:31], s[78:79]
    s_or_b64 s[28:29], s[28:29], s[30:31]
    s_cbranch_scc1 L_slow_s4
L_ok_s4:
    s_waitcnt vmcnt(1)
    v_mfma_f32_32x32x16_bf16 v[80:95], a[68:71], a[132:135], v[80:95]
    ds_read_b64_tr_b16 a[156:157], v252 offset:37888
    ds_read_b64_tr_b16 a[158:159], v252 offset:39936
    v_mfma_f32_32x32x16_bf16 v[160:175], a[48:51], a[136:139], v[160:175]
    ds_read_b64_tr_b16 a[128:129], v67 offset:0
    ds_read_b64_tr_b16 a[130:131], v67 offset:3072
    s_nop 6
    s_nop 0
    v_cvt_pk_bf16_f32 v80, v80, v81
    v_cvt_pk_bf16_f32 v81, v82, v83
    v_cvt_pk_bf16_f32 v82, v84, v85
    v_cvt_pk_bf16_f32 v83, v86, v87
    v_mfma_f32_32x32x16_bf16 v[160:175], a[52:55], a[140:143], v[160:175]
    ds_read_b64_tr_b16 a[132:133], v67 offset:1024
    ds_read_b64_tr_b16 a[134:135], v67 offset:4096
    buffer_store_dwordx4 v[80:83], v25, s[20:23], s15 offen offset:0 sc1
    v_mfma_f32_32x32x16_bf16 v[160:175], a[56:59], a[144:147], v[160:175]
    ds_read_b64_tr_b16 a[136:137], v69 offset:0
    ds_read_b64_tr_b16 a[138:139], v69 offset:3072
    v_cvt_pk_bf16_f32 v84, v88, v89
    v_cvt_pk_bf16_f32 v85, v90, v91
    v_cvt_pk_bf16_f32 v86, v92, v93
    v_cvt_pk_bf16_f32 v87, v94, v95
    v_mfma_f32_32x32x16_bf16 v[160:175], a[60:63], a[148:151], v[160:175]
    ds_read_b64_tr_b16 a[140:141], v69 offset:1024
    ds_read_b64_tr_b16 a[142:143], v69 offset:4096
    buffer_store_dwordx4 v[84:87], v25, s[20:23], s15 offen offset:1024 sc1
    s_waitcnt lgkmcnt(8)
    s_nop 0
    v_mfma_f32_32x32x16_bf16 v[160:175], a[64:67], a[152:155], v[160:175]
    ds_read_b64_tr_b16 a[144:145], v71 offset:0
    ds_read_b64_tr_b16 a[146:147], v71 offset:3072
    v_add3_u32 v88, v80, v81, s52
    v_add3_u32 v88, v82, v83, v88
    v_add3_u32 v88, v84, v85, v88
    v_add3_u32 v88, v86, v87, v88
    v_mfma_f32_32x32x16_bf16 v[160:175], a[68:71], a[156:159], v[160:175]
    ds_read_b64_tr_b16 a[148:149], v71 offset:1024
    ds_read_b64_tr_b16 a[150:151], v71 offset:4096
    s_add_u32 s68, s15, s81
    buffer_store_dword v88, v13, s[20:23], s68 offen offset:0 sc1
    s_waitcnt lgkmcnt(8)
    v_mfma_f32_32x32x16_bf16 v[224:239], a[0:3], a[128:131], v[224:239]
    ds_read_b64_tr_b16 a[152:153], v67 offset:2048
    ds_read_b64_tr_b16 a[154:155], v67 offset:5120
    s_nop 3
    v_cvt_pk_bf16_f32 v160, v160, v161
    v_cvt_pk_bf16_f32 v161, v162, v163
    v_cvt_pk_bf16_f32 v162, v164, v165
    v_cvt_pk_bf16_f32 v163, v166, v167
    v_mfma_f32_32x32x16_bf16 v[224:239], a[4:7], a[132:135], v[224:239]
    ds_read_b64_tr_b16 a[156:157], v253 offset:8192
    ds_read_b64_tr_b16 a[158:159], v253 offset:10240
    buffer_store_dwordx4 v[160:163], v25, s[20:23], s41 offen offset:0 sc1
    s_waitcnt lgkmcnt(8)
    v_mfma_f32_32x32x16_bf16 v[224:239], a[8:11], a[136:139], v[224:239]
    ds_read_b64_tr_b16 a[128:129], v69 offset:2048
    ds_read_b64_tr_b16 a[130:131], v69 offset:5120
    v_cvt_pk_bf16_f32 v164, v168, v169
    v_cvt_pk_bf16_f32 v165, v170, v171
    v_cvt_pk_bf16_f32 v166, v172, v173
    v_cvt_pk_bf16_f32 v167, v174, v175
    v_mfma_f32_32x32x16_bf16 v[224:239], a[12:15], a[140:143], v[224:239]
    ds_read_b64_tr_b16 a[132:133], v253 offset:16384
    ds_read_b64_tr_b16 a[134:135], v253 offset:18432
    buffer_store_dwordx4 v[164:167], v25, s[20:23], s41 offen offset:1024 sc1
    s_waitcnt lgkmcnt(8)
    s_nop 0
    v_mfma_f32_32x32x16_bf16 v[224:239], a[16:19], a[144:147], v[224:239]
    ds_read_b64_tr_b16 a[136:137], v71 offset:2048
    ds_read_b64_tr_b16 a[138:139], v71 offset:5120
    s_load_dwordx4 s[24:27], s[96:97], s74 offset:320
    v_add3_u32 v168, v160, v161, s52
    v_add3_u32 v168, v162, v163, v168
    v_add3_u32 v168, v164, v165, v168
    v_add3_u32 v168, v166, v167, v168
    v_mfma_f32_32x32x16_bf16 v[224:239], a[20:23], a[148:151], v[224:239]
    ds_read_b64_tr_b16 a[140:141], v253 offset:24576
    ds_read_b64_tr_b16 a[142:143], v253 offset:26624
    s_add_u32 s68, s41, s80
    buffer_store_dword v168, v13, s[20:23], s68 offen offset:256 sc1
    s_waitcnt lgkmcnt(8)
    v_mfma_f32_32x32x16_bf16 v[224:239], a[24:27], a[152:155], v[224:239]
    ds_read_b64_tr_b16 a[144:145], v253 offset:1024
    ds_read_b64_tr_b16 a[146:147], v253 offset:3072
    v_mfma_f32_32x32x16_bf16 v[224:239], a[28:31], a[156:159], v[224:239]
    ds_read_b64_tr_b16 a[148:149], v253 offset:9216
    ds_read_b64_tr_b16 a[150:151], v253 offset:11264
    s_waitcnt lgkmcnt(8)
    v_mfma_f32_32x32x16_bf16 v[224:239], a[32:35], a[128:131], v[224:239]
    ds_read_b64_tr_b16 a[152:153], v253 offset:17408
    ds_read_b64_tr_b16 a[154:155], v253 offset:19456
    v_mfma_f32_32x32x16_bf16 v[224:239], a[36:39], a[132:135], v[224:239]
    ds_read_b64_tr_b16 a[156:157], v253 offset:25600
    ds_read_b64_tr_b16 a[158:159], v253 offset:27648
    s_waitcnt lgkmcnt(8)
    v_mfma_f32_32x32x16_bf16 v[224:239], a[40:43], a[136:139], v[224:239]
    ds_read_b64_tr_b16 a[128:129], v253 offset:32768
    ds_read_b64_tr_b16 a[130:131], v253 offset:34816
    v_mfma_f32_32x32x16_bf16 v[224:239], a[44:47], a[140:143], v[224:239]
    ds_read_b64_tr_b16 a[132:133], v253 offset:33792
    ds_read_b64_tr_b16 a[134:135], v253 offset:35840
    s_waitcnt lgkmcnt(8)
    v_mfma_f32_32x32x16_bf16 v[224:239], a[48:51], a[144:147], v[224:239]
    ds_read_b128 a[136:139], v140 offset:0
    v_mfma_f32_32x32x16_bf16 v[224:239], a[52:55], a[148:151], v[224:239]
    ds_read_b128 a[140:143], v141 offset:0
    s_waitcnt lgkmcnt(6)
    v_mfma_f32_32x32x16_bf16 v[224:239], a[56:59], a[152:155], v[224:239]
    ds_read_b128 a[144:147], v140 offset:8192
    v_mfma_f32_32x32x16_bf16 v[224:239], a[60:63], a[156:159], v[224:239]
    ds_read_b128 a[148:151], v141 offset:8192
    s_waitcnt lgkmcnt(4)
    v_mfma_f32_32x32x16_bf16 v[224:239], a[64:67], a[128:131], v[224:239]
    ds_read_b128 a[152:155], v142 offset:0
    s_waitcnt lgkmcnt(0)
    s_xor_b64 s[24:25], s[24:25], s[78:79]
    s_xor_b64 s[26:27], s[26:27], s[78:79]
    s_or_b64 s[24:25], s[24:25], s[26:27]
    s_cbranch_scc1 L_slow_s7
L_ok_s7:
    v_mfma_f32_32x32x16_bf16 v[224:239], a[68:71], a[132:135], v[224:239]
    ds_read_b128 a[156:159], v143 offset:0
    v_mfma_f32_32x32x16_bf16 v[96:111], a[160:163], a[136:139], v[96:111]
    ds_read_b128 a[128:131], v142 offset:8192
    s_nop 8
    s_nop 0
    v_cvt_pk_bf16_f32 v224, v224, v225
    v_cvt_pk_bf16_f32 v225, v226, v227
    v_cvt_pk_bf16_f32 v226, v228, v229
    v_cvt_pk_bf16_f32 v227, v230, v231
    buffer_store_dwordx4 v[224:227], v25, s[20:23], s64 offen offset:0
    v_mfma_f32_32x32x16_bf16 v[96:111], a[164:167], a[140:143], v[96:111]
    ds_read_b128 a[132:135], v143 offset:8192
    v_cvt_pk_bf16_f32 v228, v232, v233
    v_cvt_pk_bf16_f32 v229, v234, v235
    v_cvt_pk_bf16_f32 v230, v236, v237
    v_cvt_pk_bf16_f32 v231, v238, v239
    v_mfma_f32_32x32x16_bf16 v[96:111], a[168:171], a[144:147], v[96:111]
    ds_read_b128 a[136:139], v140 offset:4096
    buffer_store_dwordx4 v[228:231], v25, s[20:23], s64 offen offset:1024
    v_add3_u32 v232, v224, v225, s52
    v_add3_u32 v232, v226, v227, v232
    v_add3_u32 v232, v228, v229, v232
    v_add3_u32 v232, v230, v231, v232
    v_mfma_f32_32x32x16_bf16 v[96:111], a[172:175], a[148:151], v[96:111]
    ds_read_b128 a[140:143], v141 offset:4096
    s_add_u32 s68, s64, 8192
    buffer_store_dword v232, v13, s[20:23], s68 offen offset:0
    s_waitcnt lgkmcnt(4)
    v_mfma_f32_32x32x16_bf16 v[96:111], a[72:75], a[152:155], v[96:111]
    ds_read_b128 a[144:147], v140 offset:12288
    v_mfma_f32_32x32x16_bf16 v[96:111], a[76:79], a[156:159], v[96:111]
    ds_read_b128 a[148:151], v141 offset:12288
    s_waitcnt lgkmcnt(4)
    v_mfma_f32_32x32x16_bf16 v[96:111], a[80:83], a[128:131], v[96:111]
    ds_read_b128 a[152:155], v142 offset:4096
    v_mfma_f32_32x32x16_bf16 v[96:111], a[84:87], a[132:135], v[96:111]
    ds_read_b128 a[156:159], v143 offset:4096
    s_waitcnt lgkmcnt(4)
    v_mfma_f32_32x32x16_bf16 v[96:111], a[88:91], a[136:139], v[96:111]
    ds_read_b128 a[128:131], v142 offset:12288
    s_xor_b32 s76, s43, 3
    s_sub_i32 s76, s76, s43
    s_mul_i32 s76, s76, 40960
    s_add_u32 s76, s76, s15
    buffer_load_dwordx4 v[80:83], v25, s[20:23], s76 offen sc1
    v_mfma_f32_32x32x16_bf16 v[96:111], a[92:95], a[140:143], v[96:111]
    ds_read_b128 a[132:135], v143 offset:12288
    buffer_load_dwordx4 v[84:87], v25, s[20:23], s76 offen offset:1024 sc1
    s_add_u32 s76, s76, s81
    buffer_load_dword v88, v13, s[20:23], s76 offen offset:0 sc1
    s_waitcnt lgkmcnt(4)
    v_mfma_f32_32x32x16_bf16 v[96:111], a[96:99], a[144:147], v[96:111]
    ds_read_b64_tr_b16 a[136:137], v64 offset:0
    ds_read_b64_tr_b16 a[138:139], v64 offset:3072
    v_mfma_f32_32x32x16_bf16 v[96:111], a[100:103], a[148:151], v[96:111]
    ds_read_b64_tr_b16 a[140:141], v64 offset:1024
    ds_read_b64_tr_b16 a[142:143], v64 offset:4096
    s_waitcnt lgkmcnt(6)
    v_mfma_f32_32x32x16_bf16 v[96:111], a[104:107], a[152:155], v[96:111]
    ds_read_b64_tr_b16 a[144:145], v64 offset:2048
    ds_read_b64_tr_b16 a[146:147], v64 offset:5120
    s_xor_b32 s76, s43, 2
    s_sub_i32 s76, s76, s43
    s_mul_i32 s76, s76, 40960
    s_add_u32 s76, s76, s41
    buffer_load_dwordx4 v[160:163], v25, s[20:23], s76 offen sc1
    v_mfma_f32_32x32x16_bf16 v[96:111], a[108:111], a[156:159], v[96:111]
    ds_read_b64_tr_b16 a[148:149], v252 offset:0
    ds_read_b64_tr_b16 a[150:151], v252 offset:2048
    buffer_load_dwordx4 v[164:167], v25, s[20:23], s76 offen offset:1024 sc1
    s_waitcnt lgkmcnt(8)
    v_mfma_f32_32x32x16_bf16 v[96:111], a[112:115], a[128:131], v[96:111]
    ds_read_b64_tr_b16 a[152:153], v66 offset:0
    ds_read_b64_tr_b16 a[154:155], v66 offset:3072
    s_add_u32 s76, s76, s80
    buffer_load_dword v168, v13, s[20:23], s76 offen offset:256 sc1
    v_mfma_f32_32x32x16_bf16 v[96:111], a[116:119], a[132:135], v[96:111]
    ds_read_b64_tr_b16 a[156:157], v66 offset:1024
    ds_read_b64_tr_b16 a[158:159], v66 offset:4096
    s_waitcnt lgkmcnt(8)
    v_mfma_f32_32x32x16_bf16 v[96:111], v[176:179], a[136:139], v[96:111]
    ds_read_b64_tr_b16 a[128:129], v68 offset:0
    ds_read_b64_tr_b16 a[130:131], v68 offset:3072
    v_mfma_f32_32x32x16_bf16 v[96:111], v[180:183], a[140:143], v[96:111]
    ds_read_b64_tr_b16 a[132:133], v68 offset:1024
    ds_read_b64_tr_b16 a[134:135], v68 offset:4096
    s_waitcnt lgkmcnt(8)
    v_mfma_f32_32x32x16_bf16 v[96:111], v[192:195], a[144:147], v[96:111]
    ds_read_b64_tr_b16 a[136:137], v70 offset:0
    ds_read_b64_tr_b16 a[138:139], v70 offset:3072
    s_xor_b32 s76, s43, 1
    s_sub_i32 s76, s76, s43
    s_mul_i32 s76, s76, 40960
    s_add_u32 s76, s76, s64
    buffer_load_dwordx4 v[224:227], v25, s[20:23], s76 offen sc1
    v_mfma_f32_32x32x16_bf16 v[96:111], v[196:199], a[148:151], v[96:111]
    ds_read_b64_tr_b16 a[140:141], v70 offset:1024
    ds_read_b64_tr_b16 a[142:143], v70 offset:4096
    buffer_load_dwordx4 v[228:231], v25, s[20:23], s76 offen offset:1024 sc1
    s_waitcnt lgkmcnt(8)
    v_mfma_f32_32x32x16_bf16 v[96:111], a[0:3], a[152:155], v[96:111]
    ds_read_b64_tr_b16 a[144:145], v66 offset:2048
    ds_read_b64_tr_b16 a[146:147], v66 offset:5120
    s_add_u32 s76, s76, 8192
    buffer_load_dword v232, v13, s[20:23], s76 offen offset:0 sc1
    v_mfma_f32_32x32x16_bf16 v[96:111], a[4:7], a[156:159], v[96:111]
    ds_read_b64_tr_b16 a[148:149], v252 offset:8192
    ds_read_b64_tr_b16 a[150:151], v252 offset:10240
    s_waitcnt lgkmcnt(8)
    v_mfma_f32_32x32x16_bf16 v[96:111], a[8:11], a[128:131], v[96:111]
    ds_read_b64_tr_b16 a[152:153], v68 offset:2048
    ds_read_b64_tr_b16 a[154:155], v68 offset:5120
    v_mfma_f32_32x32x16_bf16 v[96:111], a[12:15], a[132:135], v[96:111]
    ds_read_b64_tr_b16 a[156:157], v252 offset:16384
    ds_read_b64_tr_b16 a[158:159], v252 offset:18432
    s_waitcnt lgkmcnt(8)
    v_mfma_f32_32x32x16_bf16 v[96:111], a[16:19], a[136:139], v[96:111]
    ds_read_b64_tr_b16 a[128:129], v70 offset:2048
    ds_read_b64_tr_b16 a[130:131], v70 offset:5120
    v_mfma_f32_32x32x16_bf16 v[96:111], a[20:23], a[140:143], v[96:111]
    ds_read_b64_tr_b16 a[132:133], v252 offset:24576
    ds_read_b64_tr_b16 a[134:135], v252 offset:26624
    s_waitcnt lgkmcnt(8)
    v_mfma_f32_32x32x16_bf16 v[96:111], a[24:27], a[144:147], v[96:111]
    ds_read_b64_tr_b16 a[136:137], v252 offset:1024
    ds_read_b64_tr_b16 a[138:139], v252 offset:3072
    v_mfma_f32_32x32x16_bf16 v[96:111], a[28:31], a[148:151], v[96:111]
    ds_read_b64_tr_b16 a[140:141], v252 offset:9216
    ds_read_b64_tr_b16 a[142:143], v252 offset:11264
    s_waitcnt lgkmcnt(8)
    v_mfma_f32_32x32x16_bf16 v[96:111], a[32:35], a[152:155], v[96:111]
    ds_read_b64_tr_b16 a[144:145], v252 offset:17408
    ds_read_b64_tr_b16 a[146:147], v252 offset:19456
    v_mfma_f32_32x32x16_bf16 v[96:111], a[36:39], a[156:159], v[96:111]
    ds_read_b64_tr_b16 a[148:149], v252 offset:25600
    ds_read_b64_tr_b16 a[150:151], v252 offset:27648
    s_waitcnt lgkmcnt(8)
    v_mfma_f32_32x32x16_bf16 v[96:111], a[40:43], a[128:131], v[96:111]
    ds_read_b64_tr_b16 a[152:153], v252 offset:32768
    ds_read_b64_tr_b16 a[154:155], v252 offset:34816
    v_mfma_f32_32x32x16_bf16 v[96:111], a[44:47], a[132:135], v[96:111]
    ds_read_b64_tr_b16 a[156:157], v252 offset:33792
    ds_read_b64_tr_b16 a[158:159], v252 offset:35840
    s_waitcnt lgkmcnt(8)
    v_mfma_f32_32x32x16_bf16 v[96:111], a[48:51], a[136:139], v[96:111]
    v_mfma_f32_32x32x16_bf16 v[96:111], a[52:55], a[140:143], v[96:111]
    s_waitcnt lgkmcnt(4)
    v_mfma_f32_32x32x16_bf16 v[96:111], a[56:59], a[144:147], v[96:111]
    v_mfma_f32_32x32x16_bf16 v[96:111], a[60:63], a[148:151], v[96:111]
    s_waitcnt lgkmcnt(0)
    v_mfma_f32_32x32x16_bf16 v[96:111], a[64:67], a[152:155], v[96:111]
    v_mfma_f32_32x32x16_bf16 v[96:111], a[68:71], a[156:159], v[96:111]
    s_waitcnt vmcnt(8)
    v_add3_u32 v89, v80, v81, s52
    v_add3_u32 v89, v82, v83, v89
    s_waitcnt vmcnt(7)
    v_add3_u32 v89, v84, v85, v89
    v_add3_u32 v89, v86, v87, v89
    s_waitcnt vmcnt(6)
    v_xor_b32 v89, v89, v88
    s_waitcnt vmcnt(5)
    v_add3_u32 v169, v160, v161, s52
    v_add3_u32 v169, v162, v163, v169
    s_waitcnt vmcnt(4)
    v_add3_u32 v169, v164, v165, v169
    v_add3_u32 v169, v166, v167, v169
    s_waitcnt vmcnt(3)
    v_xor_b32 v169, v169, v168
    s_waitcnt vmcnt(2)
    v_add3_u32 v233, v224, v225, s52
    v_add3_u32 v233, v226, v227, v233
    s_waitcnt vmcnt(1)
    v_add3_u32 v233, v228, v229, v233
    v_add3_u32 v233, v230, v231, v233
    s_waitcnt vmcnt(0)
    v_xor_b32 v233, v233, v232
    v_or3_b32 v89, v89, v169, v233
    v_cmp_ne_u32_e64 s[88:89], 0, v89
    s_nop 1
    s_cmp_lg_u64 s[88:89], 0
    s_cbranch_scc1 L_slow_q321
L_ok_q321:
    s_add_u32 s50, s1, 0
    v_dot2_f32_bf16 v96, v80, s56, v96
    v_dot2_f32_bf16 v97, v80, s57, v97
    v_dot2_f32_bf16 v96, v160, s56, v96
    v_dot2_f32_bf16 v97, v160, s57, v97
    v_dot2_f32_bf16 v96, v224, s56, v96
    v_dot2_f32_bf16 v97, v224, s57, v97
    s_mov_b32 s49, s50
    s_nop 0
    buffer_store_dword v96, v14, s[36:39], s50 offen sc1
    s_add_u32 s50, s1, 4096
    v_dot2_f32_bf16 v98, v81, s56, v98
    v_dot2_f32_bf16 v99, v81, s57, v99
    v_dot2_f32_bf16 v98, v161, s56, v98
    v_dot2_f32_bf16 v99, v161, s57, v99
    v_dot2_f32_bf16 v98, v225, s56, v98
    v_dot2_f32_bf16 v99, v225, s57, v99
    buffer_store_dword v97, v14, s[36:39], s49 offen offset:2048 sc1
    s_mov_b32 s49, s50
    buffer_store_dword v98, v14, s[36:39], s50 offen sc1
    s_add_u32 s50, s1, 8192
    v_dot2_f32_bf16 v100, v82, s56, v100
    v_dot2_f32_bf16 v101, v82, s57, v101
    v_dot2_f32_bf16 v100, v162, s56, v100
    v_dot2_f32_bf16 v101, v162, s57, v101
    v_dot2_f32_bf16 v100, v226, s56, v100
    v_dot2_f32_bf16 v101, v226, s57, v101
    buffer_store_dword v99, v14, s[36:39], s49 offen offset:2048 sc1
    s_mov_b32 s49, s50
    buffer_store_dword v100, v14, s[36:39], s50 offen sc1
    s_add_u32 s50, s1, 12288
    v_dot2_f32_bf16 v102, v83, s56, v102
    v_dot2_f32_bf16 v103, v83, s57, v103
    v_dot2_f32_bf16 v102, v163, s56, v102
    v_dot2_f32_bf16 v103, v163, s57, v103
    v_dot2_f32_bf16 v102, v227, s56, v102
    v_dot2_f32_bf16 v103, v227, s57, v103
    buffer_store_dword v101, v14, s[36:39], s49 offen offset:2048 sc1
    s_mov_b32 s49, s50
    buffer_store_dword v102, v14, s[36:39], s50 offen sc1
    s_add_u32 s50, s1, 16384
    v_dot2_f32_bf16 v104, v84, s56, v104
    v_dot2_f32_bf16 v105, v84, s57, v105
    v_dot2_f32_bf16 v104, v164, s56, v104
    v_dot2_f32_bf16 v105, v164, s57, v105
    v_dot2_f32_bf16 v104, v228, s56, v104
    v_dot2_f32_bf16 v105, v228, s57, v105
    buffer_store_dword v103, v14, s[36:39], s49 offen offset:2048 sc1
    s_mov_b32 s49, s50
    buffer_store_dword v104, v14, s[36:39], s50 offen sc1
    s_add_u32 s50, s1, 20480
    v_dot2_f32_bf16 v106, v85, s56, v106
    v_dot2_f32_bf16 v107, v85, s57, v107
    v_dot2_f32_bf16 v106, v165, s56, v106
    v_dot2_f32_bf16 v107, v165, s57, v107
    v_dot2_f32_bf16 v106, v229, s56, v106
    v_dot2_f32_bf16 v107, v229, s57, v107
    buffer_store_dword v105, v14, s[36:39], s49 offen offset:2048 sc1
    s_mov_b32 s49, s50
    buffer_store_dword v106, v14, s[36:39], s50 offen sc1
    s_add_u32 s50, s1, 24576
    v_dot2_f32_bf16 v108, v86, s56, v108
    v_dot2_f32_bf16 v109, v86, s57, v109
    v_dot2_f32_bf16 v108, v166, s56, v108
    v_dot2_f32_bf16 v109, v166, s57, v109
    v_dot2_f32_bf16 v108, v230, s56, v108
    v_dot2_f32_bf16 v109, v230, s57, v109
    buffer_store_dword v107, v14, s[36:39], s49 offen offset:2048 sc1
    s_mov_b32 s49, s50
    buffer_store_dword v108, v14, s[36:39], s50 offen sc1
    s_add_u32 s50, s1, 28672
    v_dot2_f32_bf16 v110, v87, s56, v110
    v_dot2_f32_bf16 v111, v87, s57, v111
    v_dot2_f32_bf16 v110, v167, s56, v110
    v_dot2_f32_bf16 v111, v167, s57, v111
    v_dot2_f32_bf16 v110, v231, s56, v110
    v_dot2_f32_bf16 v111, v231, s57, v111
    buffer_store_dword v109, v14, s[36:39], s49 offen offset:2048 sc1
    s_mov_b32 s49, s50
    buffer_store_dword v110, v14, s[36:39], s50 offen sc1
    buffer_store_dword v111, v14, s[36:39], s50 offen offset:2048 sc1
    v_mov_b32 v9, s53
    s_mov_b32 s48, 2146435072
    s_cmp_eq_u32 s83, 960
    s_cselect_b32 s47, 11010048, s48
    buffer_store_dwordx2 v[8:9], v27, s[20:23], s47 offen sc1
    s_endpgm
L_slow_s3:
    s_mov_b32 s82, 0
L_slow_s3b:
    buffer_load_dword v23, v24, s[20:23], s74 offen offset:0 sc1
    s_add_u32 s82, s82, 1
    s_cmp_ge_u32 s82, 20000
    s_waitcnt vmcnt(0)
    s_cbranch_scc1 L_ok_s3
    v_cmp_ne_u32_e64 s[88:89], v23, s52
    s_nop 1
    s_and_b32 s88, s88, 0xf0000
    s_cbranch_scc1 L_slow_s3b
    s_branch L_ok_s3
L_slow_s5:
    s_mov_b32 s82, 0
L_slow_s5b:
    buffer_load_dword v23, v24, s[20:23], s74 offen offset:0 sc1
    s_add_u32 s82, s82, 1
    s_cmp_ge_u32 s82, 20000
    s_waitcnt vmcnt(0)
    s_cbranch_scc1 L_ok_s5
    v_cmp_ne_u32_e64 s[88:89], v23, s52
    s_nop 1
    s_and_b32 s88, s88, 0xff
    s_cbranch_scc1 L_slow_s5b
    s_branch L_ok_s5
L_slow_s2:
    s_mov_b32 s82, 0
L_slow_s2b:
    buffer_load_dword v23, v24, s[20:23], s74 offen offset:0 sc1
    s_add_u32 s82, s82, 1
    s_cmp_ge_u32 s82, 20000
    s_waitcnt vmcnt(0)
    s_cbranch_scc1 L_ok_s2
    v_cmp_ne_u32_e64 s[88:89], v23, s52
    s_nop 1
    s_and_b32 s88, s88, 0xf00
    s_cbranch_scc1 L_slow_s2b
    s_branch L_ok_s2
L_slow_s4:
    s_mov_b32 s82, 0
L_slow_s4b:
    buffer_load_dword v23, v24, s[20:23], s74 offen offset:0 sc1
    s_add_u32 s82, s82, 1
    s_cmp_ge_u32 s82, 20000
    s_waitcnt vmcnt(0)
    s_cbranch_scc1 L_ok_s4
    v_cmp_ne_u32_e64 s[88:89], v23, s52
    s_nop 1
    s_and_b32 s88, s88, 0xf000
    s_cbranch_scc1 L_slow_s4b
    s_branch L_ok_s4
L_slow_s7:
    s_mov_b32 s82, 0
L_slow_s7b:
    buffer_load_dword v23, v24, s[20:23], s74 offen offset:0 sc1
    s_add_u32 s82, s82, 1
    s_cmp_ge_u32 s82, 20000
    s_waitcnt vmcnt(0)
    s_cbranch_scc1 L_ok_s7
    v_cmp_ne_u32_e64 s[88:89], v23, s52
    s_nop 1
    s_and_b32 s88, s88, 0xf00000
    s_cbranch_scc1 L_slow_s7b
    s_branch L_ok_s7
L_slow_q321:
    s_mov_b32 s82, 0
L_slow_qb321:
    s_xor_b32 s76, s43, 3
    s_sub_i32 s76, s76, s43
    s_mul_i32 s76, s76, 40960
    s_add_u32 s76, s76, s15
    buffer_load_dwordx4 v[80:83], v25, s[20:23], s76 offen sc1
    buffer_load_dwordx4 v[84:87], v25, s[20:23], s76 offen offset:1024 sc1
    s_add_u32 s76, s76, s81
    buffer_load_dword v88, v13, s[20:23], s76 offen offset:0 sc1
    s_xor_b32 s76, s43, 2
    s_sub_i32 s76, s76, s43
    s_mul_i32 s76, s76, 40960
    s_add_u32 s76, s76, s41
    buffer_load_dwordx4 v[160:163], v25, s[20:23], s76 offen sc1
    buffer_load_dwordx4 v[164:167], v25, s[20:23], s76 offen offset:1024 sc1
    s_add_u32 s76, s76, s80
    buffer_load_dword v168, v13, s[20:23], s76 offen offset:256 sc1
    s_xor_b32 s76, s43, 1
    s_sub_i32 s76, s76, s43
    s_mul_i32 s76, s76, 40960
    s_add_u32 s76, s76, s64
    buffer_load_dwordx4 v[224:227], v25, s[20:23], s76 offen sc1
    buffer_load_dwordx4 v[228:231], v25, s[20:23], s76 offen offset:1024 sc1
    s_add_u32 s76, s76, 8192
    buffer_load_dword v232, v13, s[20:23], s76 offen offset:0 sc1
    s_add_u32 s82, s82, 1
    s_waitcnt vmcnt(0)
    v_add3_u32 v89, v80, v81, s52
    v_add3_u32 v89, v82, v83, v89
    v_add3_u32 v89, v84, v85, v89
    v_add3_u32 v89, v86, v87, v89
    v_xor_b32 v89, v89, v88
    v_add3_u32 v169, v160, v161, s52
    v_add3_u32 v169, v162, v163, v169
    v_add3_u32 v169, v164, v165, v169
    v_add3_u32 v169, v166, v167, v169
    v_xor_b32 v169, v169, v168
    v_add3_u32 v233, v224, v225, s52
    v_add3_u32 v233, v226, v227, v233
    v_add3_u32 v233, v228, v229, v233
    v_add3_u32 v233, v230, v231, v233
    v_xor_b32 v233, v233, v232
    v_or3_b32 v89, v89, v169, v233
    v_cmp_ne_u32_e64 s[88:89], 0, v89
    s_cmp_ge_u32 s82, 20000
    s_cbranch_scc1 L_ok_q321
    s_nop 1
    s_cmp_lg_u64 s[88:89], 0
    s_cbranch_scc1 L_slow_qb321
    s_branch L_ok_q321
L_xc0:
    ds_read_b64_tr_b16 a[248:249], v64 offset:0
    ds_read_b64_tr_b16 a[250:251], v65 offset:1024
    ds_read_b64_tr_b16 a[252:253], v64 offset:2048
    ds_read_b64_tr_b16 a[254:255], v65 offset:3072
    s_branch L_nx0
L_xc1:
    ds_read_b64_tr_b16 a[248:249], v64 offset:4096
    ds_read_b64_tr_b16 a[250:251], v65 offset:5120
    ds_read_b64_tr_b16 a[252:253], v64 offset:6144
    ds_read_b64_tr_b16 a[254:255], v65 offset:7168
    s_branch L_nx1
L_xc2:
    ds_read_b64_tr_b16 a[248:249], v64 offset:8192
    ds_read_b64_tr_b16 a[250:251], v65 offset:9216
    ds_read_b64_tr_b16 a[252:253], v64 offset:10240
    ds_read_b64_tr_b16 a[254:255], v65 offset:11264
    s_branch L_nx2
L_xc3:
    ds_read_b64_tr_b16 a[248:249], v64 offset:12288
    ds_read_b64_tr_b16 a[250:251], v65 offset:13312
    ds_read_b64_tr_b16 a[252:253], v64 offset:14336
    ds_read_b64_tr_b16 a[254:255], v65 offset:15360
    s_branch L_nx3
L_xc4:
    ds_read_b64_tr_b16 a[248:249], v64 offset:0
    ds_read_b64_tr_b16 a[250:251], v65 offset:1024
    ds_read_b64_tr_b16 a[252:253], v64 offset:2048
    ds_read_b64_tr_b16 a[254:255], v65 offset:3072
    s_branch L_nx4
L_xc5:
    ds_read_b64_tr_b16 a[248:249], v64 offset:4096
    ds_read_b64_tr_b16 a[250:251], v65 offset:5120
    ds_read_b64_tr_b16 a[252:253], v64 offset:6144
    ds_read_b64_tr_b16 a[254:255], v65 offset:7168
    s_branch L_nx5
L_xc6:
    ds_read_b64_tr_b16 a[248:249], v64 offset:8192
    ds_read_b64_tr_b16 a[250:251], v65 offset:9216
    ds_read_b64_tr_b16 a[252:253], v64 offset:10240
    ds_read_b64_tr_b16 a[254:255], v65 offset:11264
    s_branch L_nx6
L_xc7:
    ds_read_b64_tr_b16 a[248:249], v64 offset:12288
    ds_read_b64_tr_b16 a[250:251], v65 offset:13312
    ds_read_b64_tr_b16 a[252:253], v64 offset:14336
    ds_read_b64_tr_b16 a[254:255], v65 offset:15360
    s_branch L_nx7
L_fast_end:
L_slow_st:
    s_mov_b32 s82, 0
L_slow_st2:
    buffer_load_dwordx4 v[96:99], v66, s[20:23], s66 offen sc1
    buffer_load_dwordx2 v[110:111], v67, s[20:23], s76 offen offset:8 sc1
    s_add_u32 s82, s82, 1
    s_waitcnt vmcnt(0)
    v_cmp_ne_u32_e64 s[88:89], v98, s52
    s_cmp_ge_u32 s82, 20000
    s_cbranch_scc1 L_ok_st
    s_nop 1
    s_cmp_lg_u64 s[88:89], 0
    s_cbranch_scc1 L_slow_st2
    s_branch L_ok_st
L_slow_car:
    s_mov_b32 s82, 0
L_slow_car2:
    buffer_load_dwordx4 v[144:147], v9, s[84:87], s94 offen offset:0 sc1
    buffer_load_dwordx4 v[148:151], v9, s[84:87], s94 offen offset:1024 sc1
    s_add_u32 s82, s82, 1
    s_waitcnt vmcnt(0)
    v_cmp_eq_u64_e64 s[88:89], v[146:147], s[52:53]
    v_cmp_eq_u64_e64 s[92:93], v[150:151], s[52:53]
    s_nop 0
    v_cndmask_b32_e64 v2, 0, 1, s[88:89]
    v_addc_co_u32_e64 v2, s[92:93], 0, v2, s[92:93]
    v_cmp_ne_u32_e64 s[88:89], v2, v22
    s_cmp_ge_u32 s82, 20000
    s_cbranch_scc1 L_ok_car
    s_nop 1
    s_cmp_lg_u64 s[88:89], 0
    s_cbranch_scc1 L_slow_car2
    s_branch L_ok_car
L_remote:
    s_nop 15
    s_nop 7
    s_nop 0
    v_pk_mul_f32 v[80:81], v[176:177], v[176:177]
    v_pk_mul_f32 v[82:83], v[178:179], v[178:179]
    v_pk_mul_f32 v[84:85], v[180:181], v[180:181]
    v_pk_mul_f32 v[86:87], v[182:183], v[182:183]
    v_pk_mul_f32 v[88:89], v[184:185], v[184:185]
    v_pk_mul_f32 v[90:91], v[186:187], v[186:187]
    v_pk_mul_f32 v[92:93], v[188:189], v[188:189]
    v_pk_mul_f32 v[94:95], v[190:191], v[190:191]
    v_pk_fma_f32 v[80:81], v[80:81], v[248:249], v[248:249] op_sel:[0,1,0] op_sel_hi:[1,1,0]
    v_pk_fma_f32 v[82:83], v[82:83], v[248:249], v[248:249] op_sel:[0,1,0] op_sel_hi:[1,1,0]
    v_pk_fma_f32 v[84:85], v[84:85], v[248:249], v[248:249] op_sel:[0,1,0] op_sel_hi:[1,1,0]
    v_pk_fma_f32 v[86:87], v[86:87], v[248:249], v[248:249] op_sel:[0,1,0] op_sel_hi:[1,1,0]
    v_pk_fma_f32 v[88:89], v[88:89], v[248:249], v[248:249] op_sel:[0,1,0] op_sel_hi:[1,1,0]
    v_pk_fma_f32 v[90:91], v[90:91], v[248:249], v[248:249] op_sel:[0,1,0] op_sel_hi:[1,1,0]
    v_pk_fma_f32 v[92:93], v[92:93], v[248:249], v[248:249] op_sel:[0,1,0] op_sel_hi:[1,1,0]
    v_pk_fma_f32 v[94:95], v[94:95], v[248:249], v[248:249] op_sel:[0,1,0] op_sel_hi:[1,1,0]
    v_pk_mul_f32 v[80:81], v[80:81], v[176:177]
    v_pk_mul_f32 v[82:83], v[82:83], v[178:179]
    v_pk_mul_f32 v[84:85], v[84:85], v[180:181]
    s_waitcnt vmcnt(12)
    buffer_store_dword v8, v27, s[20:23], s67 offen offset:256 sc1
    v_pk_mul_f32 v[86:87], v[86:87], v[182:183]
    v_pk_mul_f32 v[88:89], v[88:89], v[184:185]
    v_pk_mul_f32 v[90:91], v[90:91], v[186:187]
    v_pk_mul_f32 v[92:93], v[92:93], v[188:189]
    v_pk_mul_f32 v[94:95], v[94:95], v[190:191]
    v_exp_f32 v80, v80
    v_exp_f32 v81, v81
    v_exp_f32 v82, v82
    v_exp_f32 v83, v83
    v_exp_f32 v84, v84
    v_exp_f32 v85, v85
    v_exp_f32 v86, v86
    v_exp_f32 v87, v87
    v_exp_f32 v88, v88
    v_exp_f32 v89, v89
    v_exp_f32 v90, v90
    v_exp_f32 v91, v91
    v_exp_f32 v92, v92
    v_exp_f32 v93, v93
    v_exp_f32 v94, v94
    v_exp_f32_e64 v95, v95
    v_pk_fma_f32 v[80:81], v[80:81], v[250:251], v[250:251] op_sel_hi:[1,0,0]
    v_pk_fma_f32 v[82:83], v[82:83], v[250:251], v[250:251] op_sel_hi:[1,0,0]
    v_pk_fma_f32 v[84:85], v[84:85], v[250:251], v[250:251] op_sel_hi:[1,0,0]
    v_pk_fma_f32 v[86:87], v[86:87], v[250:251], v[250:251] op_sel_hi:[1,0,0]
    v_pk_fma_f32 v[88:89], v[88:89], v[250:251], v[250:251] op_sel_hi:[1,0,0]
    v_pk_fma_f32 v[90:91], v[90:91], v[250:251], v[250:251] op_sel_hi:[1,0,0]
    v_pk_fma_f32 v[92:93], v[92:93], v[250:251], v[250:251] op_sel_hi:[1,0,0]
    v_pk_fma_f32 v[94:95], v[94:95], v[250:251], v[250:251] op_sel_hi:[1,0,0]
    v_rcp_f32 v80, v80
    v_rcp_f32 v81, v81
    v_rcp_f32 v82, v82
    v_rcp_f32 v83, v83
    v_rcp_f32 v84, v84
    v_rcp_f32 v85, v85
    v_rcp_f32 v86, v86
    v_rcp_f32 v87, v87
    v_rcp_f32 v88, v88
    v_rcp_f32 v89, v89
    v_rcp_f32 v90, v90
    v_rcp_f32 v91, v91
    v_rcp_f32 v92, v92
    v_rcp_f32 v93, v93
    v_rcp_f32 v94, v94
    v_rcp_f32 v95, v95
    v_pk_mul_f32 v[80:81], v[80:81], v[176:177]
    v_pk_mul_f32 v[82:83], v[82:83], v[178:179]
    v_pk_mul_f32 v[84:85], v[84:85], v[180:181]
    v_pk_mul_f32 v[86:87], v[86:87], v[182:183]
    v_pk_mul_f32 v[88:89], v[88:89], v[184:185]
    v_pk_mul_f32 v[90:91], v[90:91], v[186:187]
    v_pk_mul_f32 v[92:93], v[92:93], v[188:189]
    v_pk_mul_f32 v[94:95], v[94:95], v[190:191]
    v_cvt_pk_bf16_f32 v176, v80, v81
    v_cvt_pk_bf16_f32 v177, v82, v83
    v_cvt_pk_bf16_f32 v178, v84, v85
    v_cvt_pk_bf16_f32 v179, v86, v87
    buffer_store_dwordx4 v[176:179], v25, s[20:23], s64 offen sc1
    v_cvt_pk_bf16_f32 v180, v88, v89
    v_cvt_pk_bf16_f32 v181, v90, v91
    v_cvt_pk_bf16_f32 v182, v92, v93
    v_cvt_pk_bf16_f32 v183, v94, v95
    buffer_store_dwordx4 v[180:183], v25, s[20:23], s64 offen offset:1024 sc1
    v_pk_mul_f32 v[80:81], v[192:193], v[192:193]
    v_pk_mul_f32 v[82:83], v[194:195], v[194:195]
    v_pk_mul_f32 v[84:85], v[196:197], v[196:197]
    v_pk_mul_f32 v[86:87], v[198:199], v[198:199]
    v_pk_mul_f32 v[88:89], v[200:201], v[200:201]
    v_pk_mul_f32 v[90:91], v[202:203], v[202:203]
    v_pk_mul_f32 v[92:93], v[204:205], v[204:205]
    v_pk_mul_f32 v[94:95], v[206:207], v[206:207]
    v_pk_fma_f32 v[80:81], v[80:81], v[248:249], v[248:249] op_sel:[0,1,0] op_sel_hi:[1,1,0]
    v_pk_fma_f32 v[82:83], v[82:83], v[248:249], v[248:249] op_sel:[0,1,0] op_sel_hi:[1,1,0]
    v_pk_fma_f32 v[84:85], v[84:85], v[248:249], v[248:249] op_sel:[0,1,0] op_sel_hi:[1,1,0]
    v_pk_fma_f32 v[86:87], v[86:87], v[248:249], v[248:249] op_sel:[0,1,0] op_sel_hi:[1,1,0]
    v_pk_fma_f32 v[88:89], v[88:89], v[248:249], v[248:249] op_sel:[0,1,0] op_sel_hi:[1,1,0]
    v_pk_fma_f32 v[90:91], v[90:91], v[248:249], v[248:249] op_sel:[0,1,0] op_sel_hi:[1,1,0]
    v_pk_fma_f32 v[92:93], v[92:93], v[248:249], v[248:249] op_sel:[0,1,0] op_sel_hi:[1,1,0]
    v_pk_fma_f32 v[94:95], v[94:95], v[248:249], v[248:249] op_sel:[0,1,0] op_sel_hi:[1,1,0]
    v_pk_mul_f32 v[80:81], v[80:81], v[192:193]
    v_pk_mul_f32 v[82:83], v[82:83], v[194:195]
    v_pk_mul_f32 v[84:85], v[84:85], v[196:197]
    v_pk_mul_f32 v[86:87], v[86:87], v[198:199]
    v_pk_mul_f32 v[88:89], v[88:89], v[200:201]
    v_pk_mul_f32 v[90:91], v[90:91], v[202:203]
    v_pk_mul_f32 v[92:93], v[92:93], v[204:205]
    v_pk_mul_f32 v[94:95], v[94:95], v[206:207]
    v_exp_f32 v80, v80
    v_exp_f32 v81, v81
    v_exp_f32 v82, v82
    v_exp_f32 v83, v83
    v_exp_f32 v84, v84
    v_exp_f32 v85, v85
    v_exp_f32 v86, v86
    v_exp_f32 v87, v87
    v_exp_f32 v88, v88
    v_exp_f32 v89, v89
    v_exp_f32 v90, v90
    v_exp_f32 v91, v91
    v_exp_f32 v92, v92
    v_exp_f32 v93, v93
    v_exp_f32 v94, v94
    v_exp_f32 v95, v95
    v_pk_fma_f32 v[80:81], v[80:81], v[250:251], v[250:251] op_sel_hi:[1,0,0]
    v_pk_fma_f32 v[82:83], v[82:83], v[250:251], v[250:251] op_sel_hi:[1,0,0]
    v_pk_fma_f32 v[84:85], v[84:85], v[250:251], v[250:251] op_sel_hi:[1,0,0]
    v_pk_fma_f32 v[86:87], v[86:87], v[250:251], v[250:251] op_sel_hi:[1,0,0]
    v_pk_fma_f32 v[88:89], v[88:89], v[250:251], v[250:251] op_sel_hi:[1,0,0]
    v_pk_fma_f32 v[90:91], v[90:91], v[250:251], v[250:251] op_sel_hi:[1,0,0]
    v_pk_fma_f32 v[92:93], v[92:93], v[250:251], v[250:251] op_sel_hi:[1,0,0]
    v_pk_fma_f32 v[94:95], v[94:95], v[250:251], v[250:251] op_sel_hi:[1,0,0]
    v_rcp_f32 v80, v80
    v_rcp_f32 v81, v81
    v_rcp_f32 v82, v82
    v_rcp_f32 v83, v83
    v_rcp_f32 v84, v84
    v_rcp_f32 v85, v85
    v_rcp_f32 v86, v86
    v_rcp_f32 v87, v87
    v_rcp_f32 v88, v88
    v_rcp_f32 v89, v89
    v_rcp_f32 v90, v90
    v_rcp_f32 v91, v91
    v_rcp_f32 v92, v92
    v_rcp_f32 v93, v93
    v_rcp_f32 v94, v94
    v_rcp_f32 v95, v95
    v_pk_mul_f32 v[80:81], v[80:81], v[192:193]
    v_pk_mul_f32 v[82:83], v[82:83], v[194:195]
    v_pk_mul_f32 v[84:85], v[84:85], v[196:197]
    v_pk_mul_f32 v[86:87], v[86:87], v[198:199]
    v_pk_mul_f32 v[88:89], v[88:89], v[200:201]
    v_pk_mul_f32 v[90:91], v[90:91], v[202:203]
    v_pk_mul_f32 v[92:93], v[92:93], v[204:205]
    v_pk_mul_f32 v[94:95], v[94:95], v[206:207]
    v_cvt_pk_bf16_f32 v192, v80, v81
    v_cvt_pk_bf16_f32 v193, v82, v83
    v_cvt_pk_bf16_f32 v194, v84, v85
    v_cvt_pk_bf16_f32 v195, v86, v87
    buffer_store_dwordx4 v[192:195], v25, s[20:23], s13 offen sc1
    v_cvt_pk_bf16_f32 v196, v88, v89
    v_cvt_pk_bf16_f32 v197, v90, v91
    v_cvt_pk_bf16_f32 v198, v92, v93
    v_cvt_pk_bf16_f32 v199, v94, v95
    buffer_store_dwordx4 v[196:199], v25, s[20:23], s13 offen offset:1024 sc1
    v_pk_mul_f32 v[80:81], v[208:209], v[208:209]
    v_pk_mul_f32 v[82:83], v[210:211], v[210:211]
    v_pk_mul_f32 v[84:85], v[212:213], v[212:213]
    v_pk_mul_f32 v[86:87], v[214:215], v[214:215]
    v_pk_mul_f32 v[88:89], v[216:217], v[216:217]
    v_pk_mul_f32 v[90:91], v[218:219], v[218:219]
    v_pk_mul_f32 v[92:93], v[220:221], v[220:221]
    v_pk_mul_f32 v[94:95], v[222:223], v[222:223]
    v_pk_fma_f32 v[80:81], v[80:81], v[248:249], v[248:249] op_sel:[0,1,0] op_sel_hi:[1,1,0]
    v_pk_fma_f32 v[82:83], v[82:83], v[248:249], v[248:249] op_sel:[0,1,0] op_sel_hi:[1,1,0]
    v_pk_fma_f32 v[84:85], v[84:85], v[248:249], v[248:249] op_sel:[0,1,0] op_sel_hi:[1,1,0]
    v_pk_fma_f32 v[86:87], v[86:87], v[248:249], v[248:249] op_sel:[0,1,0] op_sel_hi:[1,1,0]
    v_pk_fma_f32 v[88:89], v[88:89], v[248:249], v[248:249] op_sel:[0,1,0] op_sel_hi:[1,1,0]
    v_pk_fma_f32 v[90:91], v[90:91], v[248:249], v[248:249] op_sel:[0,1,0] op_sel_hi:[1,1,0]
    v_pk_fma_f32 v[92:93], v[92:93], v[248:249], v[248:249] op_sel:[0,1,0] op_sel_hi:[1,1,0]
    v_pk_fma_f32 v[94:95], v[94:95], v[248:249], v[248:249] op_sel:[0,1,0] op_sel_hi:[1,1,0]
    v_pk_mul_f32 v[80:81], v[80:81], v[208:209]
    v_pk_mul_f32 v[82:83], v[82:83], v[210:211]
    v_pk_mul_f32 v[84:85], v[84:85], v[212:213]
    v_pk_mul_f32 v[86:87], v[86:87], v[214:215]
    v_pk_mul_f32 v[88:89], v[88:89], v[216:217]
    v_pk_mul_f32 v[90:91], v[90:91], v[218:219]
    v_pk_mul_f32 v[92:93], v[92:93], v[220:221]
    v_pk_mul_f32 v[94:95], v[94:95], v[222:223]
    v_exp_f32 v80, v80
    v_exp_f32 v81, v81
    v_exp_f32 v82, v82
    v_exp_f32 v83, v83
    v_exp_f32 v84, v84
    v_exp_f32 v85, v85
    v_exp_f32 v86, v86
    v_exp_f32 v87, v87
    v_exp_f32 v88, v88
    v_exp_f32 v89, v89
    v_exp_f32 v90, v90
    v_exp_f32 v91, v91
    v_exp_f32 v92, v92
    v_exp_f32 v93, v93
    v_exp_f32 v94, v94
    v_exp_f32 v95, v95
    v_pk_fma_f32 v[80:81], v[80:81], v[250:251], v[250:251] op_sel_hi:[1,0,0]
    v_pk_fma_f32 v[82:83], v[82:83], v[250:251], v[250:251] op_sel_hi:[1,0,0]
    v_pk_fma_f32 v[84:85], v[84:85], v[250:251], v[250:251] op_sel_hi:[1,0,0]
    v_pk_fma_f32 v[86:87], v[86:87], v[250:251], v[250:251] op_sel_hi:[1,0,0]
    v_pk_fma_f32 v[88:89], v[88:89], v[250:251], v[250:251] op_sel_hi:[1,0,0]
    v_pk_fma_f32 v[90:91], v[90:91], v[250:251], v[250:251] op_sel_hi:[1,0,0]
    v_pk_fma_f32 v[92:93], v[92:93], v[250:251], v[250:251] op_sel_hi:[1,0,0]
    v_pk_fma_f32 v[94:95], v[94:95], v[250:251], v[250:251] op_sel_hi:[1,0,0]
    v_rcp_f32 v80, v80
    v_rcp_f32 v81, v81
    v_rcp_f32 v82, v82
    v_rcp_f32 v83, v83
    v_rcp_f32 v84, v84
    v_rcp_f32 v85, v85
    v_rcp_f32 v86, v86
    s_load_dwordx4 s[16:19], s[96:97], s74 offset:256
    v_rcp_f32 v87, v87
    v_rcp_f32 v88, v88
    v_rcp_f32 v89, v89
    v_rcp_f32 v90, v90
    v_rcp_f32 v91, v91
    v_rcp_f32 v92, v92
    v_rcp_f32 v93, v93
    v_rcp_f32 v94, v94
    v_rcp_f32 v95, v95
    v_pk_mul_f32 v[80:81], v[80:81], v[208:209]
    v_pk_mul_f32 v[82:83], v[82:83], v[210:211]
    v_pk_mul_f32 v[84:85], v[84:85], v[212:213]
    v_pk_mul_f32 v[86:87], v[86:87], v[214:215]
    v_pk_mul_f32 v[88:89], v[88:89], v[216:217]
    v_pk_mul_f32 v[90:91], v[90:91], v[218:219]
    v_pk_mul_f32 v[92:93], v[92:93], v[220:221]
    v_pk_mul_f32 v[94:95], v[94:95], v[222:223]
    s_waitcnt vmcnt(2)
    s_nop 0
    buffer_store_dword v8, v27, s[20:23], s67 offen offset:0 sc1
    v_cvt_pk_bf16_f32 v208, v80, v81
    v_cvt_pk_bf16_f32 v209, v82, v83
    v_cvt_pk_bf16_f32 v210, v84, v85
    v_cvt_pk_bf16_f32 v211, v86, v87
    buffer_store_dwordx4 v[208:211], v25, s[20:23], s14 offen sc1
    v_cvt_pk_bf16_f32 v212, v88, v89
    v_cvt_pk_bf16_f32 v213, v90, v91
    v_cvt_pk_bf16_f32 v214, v92, v93
    v_cvt_pk_bf16_f32 v215, v94, v95
    buffer_store_dwordx4 v[212:215], v25, s[20:23], s14 offen offset:1024 sc1
    s_barrier
    ds_read_b128 a[128:131], v140 offset:49152
    ds_read_b128 a[132:135], v140 offset:32768
    ds_read_b128 a[136:139], v140 offset:16384
    ds_read_b128 a[140:143], v141 offset:49152
    ds_read_b128 a[144:147], v141 offset:32768
    ds_read_b128 a[148:151], v141 offset:16384
    s_waitcnt lgkmcnt(5)
    v_mfma_f32_32x32x16_bf16 v[80:95], a[160:163], a[128:131], 0
    ds_read_b128 a[152:155], v140 offset:57344
    s_and_b32 s47, s3, 3
    s_lshl_b32 s47, s47, 3
    s_lshr_b32 s47, 0x398db1e4, s47
    ds_read_b128 v[96:99], v251 offset:128
    ds_read_b128 v[100:103], v251 offset:144
    s_waitcnt lgkmcnt(7)
    v_mfma_f32_32x32x16_bf16 v[160:175], a[160:163], a[132:135], 0
    ds_read_b128 a[156:159], v140 offset:40960
    s_bfe_u32 s48, s47, 0x20000
    s_mul_i32 s48, s48, 12288
    v_add_u32 v64, s48, v254
    v_add_u32 v65, s48, v255
    s_waitcnt lgkmcnt(6)
    v_mfma_f32_32x32x16_bf16 v[224:239], a[160:163], a[136:139], 0
    ds_read_b128 a[128:131], v140 offset:24576
    ds_read_b128 v[104:107], v251 offset:160
    ds_read_b128 v[108:111], v251 offset:176
    v_mfma_f32_32x32x16_bf16 v[80:95], a[164:167], a[140:143], v[80:95]
    ds_read_b128 a[132:135], v141 offset:57344
    s_waitcnt lgkmcnt(8)
    v_mfma_f32_32x32x16_bf16 v[160:175], a[164:167], a[144:147], v[160:175]
    ds_read_b128 a[136:139], v141 offset:40960
    s_waitcnt vmcnt(3)
    buffer_store_dword v8, v27, s[20:23], s67 offen offset:64 sc1
    v_accvgpr_read_b32 v48, a246
    v_accvgpr_read_b32 v49, a247
    v_mfma_f32_32x32x16_bf16 v[224:239], a[164:167], a[148:151], v[224:239]
    ds_read_b128 a[140:143], v141 offset:24576
    s_waitcnt lgkmcnt(0)
    s_xor_b64 s[16:17], s[16:17], s[78:79]
    s_xor_b64 s[18:19], s[18:19], s[78:79]
    s_or_b64 s[16:17], s[16:17], s[18:19]
    s_cbranch_scc1 L_slow_s3_r
L_ok_s3_r:
    buffer_load_dwordx4 a[72:75], v15, s[20:23], s11 offen offset:0 sc1
    v_mfma_f32_32x32x16_bf16 v[80:95], a[168:171], a[152:155], v[80:95]
    ds_read_b64_tr_b16 a[144:145], v65 offset:6144
    ds_read_b64_tr_b16 a[146:147], v65 offset:9216
    buffer_load_dwordx4 a[76:79], v15, s[20:23], s11 offen offset:1024 sc1
    v_lshlrev_b32 v48, 16, v48
    v_lshlrev_b32 v49, 16, v49
    v_mfma_f32_32x32x16_bf16 v[160:175], a[168:171], a[156:159], v[160:175]
    ds_read_b64_tr_b16 a[148:149], v64 offset:6144
    ds_read_b64_tr_b16 a[150:151], v64 offset:9216
    buffer_load_dwordx4 a[80:83], v15, s[20:23], s12 offen offset:0 sc1
    v_mfma_f32_32x32x16_bf16 v[224:239], a[168:171], a[128:131], v[224:239]
    ds_read_b64_tr_b16 a[152:153], v65 offset:0
    ds_read_b64_tr_b16 a[154:155], v65 offset:3072
    v_accvgpr_read_b32 v51, a248
    v_lshlrev_b32 v50, 16, v51
    v_and_b32 v51, 0xffff0000, v51
    v_mfma_f32_32x32x16_bf16 v[80:95], a[172:175], a[132:135], v[80:95]
    ds_read_b64_tr_b16 a[156:157], v65 offset:7168
    ds_read_b64_tr_b16 a[158:159], v65 offset:10240
    buffer_load_dwordx4 a[84:87], v15, s[20:23], s12 offen offset:1024 sc1
    v_mfma_f32_32x32x16_bf16 v[160:175], a[172:175], a[136:139], v[160:175]
    ds_read_b64_tr_b16 a[128:129], v64 offset:7168
    ds_read_b64_tr_b16 a[130:131], v64 offset:10240
    v_fma_f32 v96, v50, v116, -v96
    v_add_f32 v50, v50, v49
    v_fma_f32 v96, v96, v48, v50
    v_mfma_f32_32x32x16_bf16 v[224:239], a[172:175], a[140:143], v[224:239]
    ds_read_b64_tr_b16 a[132:133], v65 offset:1024
    ds_read_b64_tr_b16 a[134:135], v65 offset:4096
    buffer_load_dwordx4 a[88:91], v16, s[20:23], s11 offen offset:0 sc1
    s_waitcnt lgkmcnt(8)
    v_mfma_f32_32x32x16_bf16 v[80:95], v[176:179], a[144:147], v[80:95]
    ds_read_b64_tr_b16 a[136:137], v65 offset:8192
    ds_read_b64_tr_b16 a[138:139], v65 offset:11264
    v_fma_f32 v97, v51, v117, -v97
    v_add_f32 v51, v51, v49
    v_fma_f32 v97, v97, v48, v51
    v_mfma_f32_32x32x16_bf16 v[160:175], v[176:179], a[148:151], v[160:175]
    ds_read_b64_tr_b16 a[140:141], v64 offset:8192
    ds_read_b64_tr_b16 a[142:143], v64 offset:11264
    buffer_load_dwordx4 a[92:95], v16, s[20:23], s11 offen offset:1024 sc1
    s_waitcnt lgkmcnt(8)
    v_mfma_f32_32x32x16_bf16 v[224:239], v[176:179], a[152:155], v[224:239]
    ds_read_b64_tr_b16 a[144:145], v65 offset:2048
    ds_read_b64_tr_b16 a[146:147], v65 offset:5120
    v_accvgpr_read_b32 v51, a249
    v_lshlrev_b32 v50, 16, v51
    v_and_b32 v51, 0xffff0000, v51
    v_mfma_f32_32x32x16_bf16 v[80:95], v[180:183], a[156:159], v[80:95]
    ds_read_b64_tr_b16 a[148:149], v253 offset:4096
    ds_read_b64_tr_b16 a[150:151], v253 offset:6144
    buffer_load_dwordx4 a[96:99], v16, s[20:23], s12 offen offset:0 sc1
    s_waitcnt lgkmcnt(8)
    v_mfma_f32_32x32x16_bf16 v[160:175], v[180:183], a[128:131], v[160:175]
    ds_read_b64_tr_b16 a[152:153], v252 offset:4096
    ds_read_b64_tr_b16 a[154:155], v252 offset:6144
    v_fma_f32 v98, v50, v118, -v98
    v_add_f32 v50, v50, v49
    v_fma_f32 v98, v98, v48, v50
    v_mfma_f32_32x32x16_bf16 v[224:239], v[180:183], a[132:135], v[224:239]
    ds_read_b64_tr_b16 a[156:157], v253 offset:0
    ds_read_b64_tr_b16 a[158:159], v253 offset:2048
    buffer_load_dwordx4 a[100:103], v16, s[20:23], s12 offen offset:1024 sc1
    s_waitcnt lgkmcnt(8)
    v_mfma_f32_32x32x16_bf16 v[80:95], v[192:195], a[136:139], v[80:95]
    ds_read_b128 a[128:131], v142 offset:49152
    v_fma_f32 v99, v51, v119, -v99
    v_add_f32 v51, v51, v49
    v_fma_f32 v99, v99, v48, v51
    v_accvgpr_read_b32 v51, a250
    v_lshlrev_b32 v50, 16, v51
    v_and_b32 v51, 0xffff0000, v51
    v_mfma_f32_32x32x16_bf16 v[160:175], v[192:195], a[140:143], v[160:175]
    ds_read_b128 a[132:135], v142 offset:32768
    buffer_load_dwordx4 a[104:107], v17, s[20:23], s11 offen offset:0 sc1
    v_fma_f32 v100, v50, v120, -v100
    v_add_f32 v50, v50, v49
    v_fma_f32 v100, v100, v48, v50
    s_waitcnt lgkmcnt(6)
    v_mfma_f32_32x32x16_bf16 v[224:239], v[192:195], a[144:147], v[224:239]
    ds_read_b128 a[136:139], v142 offset:16384
    s_waitcnt vmcnt(10)
    buffer_store_dword v8, v27, s[20:23], s67 offen offset:128 sc1
    v_fma_f32 v101, v51, v121, -v101
    v_add_f32 v51, v51, v49
    v_fma_f32 v101, v101, v48, v51
    v_mfma_f32_32x32x16_bf16 v[80:95], v[196:199], a[148:151], v[80:95]
    ds_read_b128 a[140:143], v143 offset:49152
    buffer_load_dwordx4 a[108:111], v17, s[20:23], s11 offen offset:1024 sc1
    v_accvgpr_read_b32 v51, a251
    v_lshlrev_b32 v50, 16, v51
    v_and_b32 v51, 0xffff0000, v51
    s_waitcnt lgkmcnt(4)
    v_mfma_f32_32x32x16_bf16 v[160:175], v[196:199], a[152:155], v[160:175]
    ds_read_b128 a[144:147], v143 offset:32768
    v_fma_f32 v102, v50, v122, -v102
    v_add_f32 v50, v50, v49
    v_fma_f32 v102, v102, v48, v50
    v_fma_f32 v103, v51, v123, -v103
    v_add_f32 v51, v51, v49
    v_fma_f32 v103, v103, v48, v51
    v_mfma_f32_32x32x16_bf16 v[224:239], v[196:199], a[156:159], v[224:239]
    ds_read_b128 a[148:151], v143 offset:16384
    buffer_load_dwordx4 a[112:115], v17, s[20:23], s12 offen offset:0 sc1
    v_accvgpr_read_b32 v51, a252
    v_lshlrev_b32 v50, 16, v51
    v_and_b32 v51, 0xffff0000, v51
    s_waitcnt lgkmcnt(4)
    s_waitcnt vmcnt(11)
    v_mfma_f32_32x32x16_bf16 v[80:95], a[72:75], a[128:131], v[80:95]
    ds_read_b128 a[152:155], v142 offset:57344
    v_fma_f32 v104, v50, v124, -v104
    v_add_f32 v50, v50, v49
    v_fma_f32 v104, v104, v48, v50
    v_fma_f32 v105, v51, v125, -v105
    v_add_f32 v51, v51, v49
    v_fma_f32 v105, v105, v48, v51
    v_mfma_f32_32x32x16_bf16 v[160:175], a[72:75], a[132:135], v[160:175]
    ds_read_b128 a[156:159], v142 offset:40960
    buffer_load_dwordx4 a[116:119], v17, s[20:23], s12 offen offset:1024 sc1
    v_accvgpr_read_b32 v51, a253
    v_lshlrev_b32 v50, 16, v51
    v_and_b32 v51, 0xffff0000, v51
    s_waitcnt lgkmcnt(4)
    v_mfma_f32_32x32x16_bf16 v[224:239], a[72:75], a[136:139], v[224:239]
    ds_read_b128 a[128:131], v142 offset:24576
    v_fma_f32 v106, v50, v126, -v106
    v_add_f32 v50, v50, v49
    v_fma_f32 v106, v106, v48, v50
    v_fma_f32 v107, v51, v127, -v107
    v_add_f32 v51, v51, v49
    v_fma_f32 v107, v107, v48, v51
    s_waitcnt vmcnt(11)
    v_mfma_f32_32x32x16_bf16 v[80:95], a[76:79], a[140:143], v[80:95]
    ds_read_b128 a[132:135], v143 offset:57344
    v_accvgpr_read_b32 v51, a254
    v_lshlrev_b32 v50, 16, v51
    v_and_b32 v51, 0xffff0000, v51
    s_waitcnt lgkmcnt(4)
    v_mfma_f32_32x32x16_bf16 v[160:175], a[76:79], a[144:147], v[160:175]
    ds_read_b128 a[136:139], v143 offset:40960
    s_load_dwordx4 s[24:27], s[96:97], s74 offset:0
    s_load_dwordx4 s[28:31], s[96:97], s74 offset:64
    v_fma_f32 v108, v50, v128, -v108
    v_add_f32 v50, v50, v49
    v_fma_f32 v108, v108, v48, v50
    v_mfma_f32_32x32x16_bf16 v[224:239], a[76:79], a[148:151], v[224:239]
    s_barrier
    ds_read_b128 a[140:143], v143 offset:24576
    s_waitcnt lgkmcnt(4)
    s_waitcnt vmcnt(10)
    v_mfma_f32_32x32x16_bf16 v[80:95], a[80:83], a[152:155], v[80:95]
    ds_read_b128 a[144:147], v140 offset:53248
    v_fma_f32 v109, v51, v129, -v109
    v_add_f32 v51, v51, v49
    v_fma_f32 v109, v109, v48, v51
    v_accvgpr_read_b32 v51, a255
    v_lshlrev_b32 v50, 16, v51
    v_and_b32 v51, 0xffff0000, v51
    v_mfma_f32_32x32x16_bf16 v[160:175], a[80:83], a[156:159], v[160:175]
    ds_read_b128 a[148:151], v140 offset:36864
    v_fma_f32 v110, v50, v130, -v110
    v_add_f32 v50, v50, v49
    v_fma_f32 v110, v110, v48, v50
    s_waitcnt lgkmcnt(4)
    v_mfma_f32_32x32x16_bf16 v[224:239], a[80:83], a[128:131], v[224:239]
    ds_read_b128 a[152:155], v140 offset:20480
    v_fma_f32 v111, v51, v131, -v111
    v_add_f32 v51, v51, v49
    v_fma_f32 v111, v111, v48, v51
    s_waitcnt vmcnt(9)
    v_mfma_f32_32x32x16_bf16 v[80:95], a[84:87], a[132:135], v[80:95]
    ds_read_b128 a[156:159], v141 offset:53248
    s_waitcnt lgkmcnt(4)
    v_mfma_f32_32x32x16_bf16 v[160:175], a[84:87], a[136:139], v[160:175]
    ds_read_b128 a[128:131], v141 offset:36864
    v_mfma_f32_32x32x16_bf16 v[224:239], a[84:87], a[140:143], v[224:239]
    ds_read_b128 a[132:135], v141 offset:20480
    s_waitcnt lgkmcnt(4)
    s_waitcnt vmcnt(8)
    v_mfma_f32_32x32x16_bf16 v[80:95], a[88:91], a[144:147], v[80:95]
    ds_read_b128 a[136:139], v140 offset:61440
    v_mfma_f32_32x32x16_bf16 v[160:175], a[88:91], a[148:151], v[160:175]
    ds_read_b128 a[140:143], v140 offset:45056
    s_waitcnt lgkmcnt(4)
    v_mfma_f32_32x32x16_bf16 v[224:239], a[88:91], a[152:155], v[224:239]
    ds_read_b128 a[144:147], v140 offset:28672
    s_waitcnt lgkmcnt(0)
    s_xor_b64 s[24:25], s[24:25], s[78:79]
    s_xor_b64 s[26:27], s[26:27], s[78:79]
    s_xor_b64 s[28:29], s[28:29], s[78:79]
    s_xor_b64 s[30:31], s[30:31], s[78:79]
    s_or_b64 s[24:25], s[24:25], s[26:27]
    s_or_b64 s[24:25], s[24:25], s[28:29]
    s_or_b64 s[24:25], s[24:25], s[30:31]
    s_cbranch_scc1 L_slow_s5_r
L_ok_s5_r:
    buffer_load_dwordx4 a[0:3], v15, s[20:23], s77 offen offset:0 sc1
    s_waitcnt vmcnt(8)
    v_mfma_f32_32x32x16_bf16 v[80:95], a[92:95], a[156:159], v[80:95]
    ds_read_b128 a[148:151], v141 offset:61440
    buffer_load_dwordx4 a[4:7], v15, s[20:23], s77 offen offset:1024 sc1
    v_mfma_f32_32x32x16_bf16 v[160:175], a[92:95], a[128:131], v[160:175]
    ds_read_b128 a[152:155], v141 offset:45056
    buffer_load_dwordx4 a[8:11], v16, s[20:23], s77 offen offset:0 sc1
    v_mfma_f32_32x32x16_bf16 v[224:239], a[92:95], a[132:135], v[224:239]
    ds_read_b128 a[156:159], v141 offset:28672
    s_waitcnt vmcnt(9)
    v_mfma_f32_32x32x16_bf16 v[80:95], a[96:99], a[136:139], v[80:95]
    ds_read_b128 a[128:131], v142 offset:53248
    buffer_load_dwordx4 a[12:15], v16, s[20:23], s77 offen offset:1024 sc1
    v_mfma_f32_32x32x16_bf16 v[160:175], a[96:99], a[140:143], v[160:175]
    ds_read_b128 a[132:135], v142 offset:36864
    s_waitcnt lgkmcnt(4)
    v_mfma_f32_32x32x16_bf16 v[224:239], a[96:99], a[144:147], v[224:239]
    ds_read_b128 a[136:139], v142 offset:20480
    buffer_load_dwordx4 a[16:19], v17, s[20:23], s77 offen offset:0 sc1
    s_waitcnt vmcnt(10)
    v_mfma_f32_32x32x16_bf16 v[80:95], a[100:103], a[148:151], v[80:95]
    ds_read_b128 a[140:143], v143 offset:53248
    s_waitcnt lgkmcnt(4)
    v_mfma_f32_32x32x16_bf16 v[160:175], a[100:103], a[152:155], v[160:175]
    ds_read_b128 a[144:147], v143 offset:36864
    buffer_load_dwordx4 a[20:23], v17, s[20:23], s77 offen offset:1024 sc1
    v_mfma_f32_32x32x16_bf16 v[224:239], a[100:103], a[156:159], v[224:239]
    ds_read_b128 a[148:151], v143 offset:20480
    s_waitcnt lgkmcnt(4)
    s_waitcnt vmcnt(10)
    v_mfma_f32_32x32x16_bf16 v[80:95], a[104:107], a[128:131], v[80:95]
    ds_read_b128 a[152:155], v142 offset:61440
    s_waitcnt vmcnt(6)
    buffer_store_dword v8, v27, s[20:23], s67 offen offset:192 sc1
    buffer_load_dwordx4 a[24:27], v15, s[20:23], s8 offen offset:0 sc1
    v_mfma_f32_32x32x16_bf16 v[160:175], a[104:107], a[132:135], v[160:175]
    ds_read_b128 a[156:159], v142 offset:45056
    s_bfe_u32 s48, s47, 0x20002
    s_mul_i32 s48, s48, 12288
    v_add_u32 v66, s48, v254
    v_add_u32 v67, s48, v255
    s_waitcnt lgkmcnt(4)
    v_mfma_f32_32x32x16_bf16 v[224:239], a[104:107], a[136:139], v[224:239]
    ds_read_b128 a[128:131], v142 offset:28672
    buffer_load_dwordx4 a[28:31], v15, s[20:23], s8 offen offset:1024 sc1
    s_bfe_u32 s48, s47, 0x20004
    s_mul_i32 s48, s48, 12288
    v_add_u32 v68, s48, v254
    v_add_u32 v69, s48, v255
    v_mfma_f32_32x32x16_bf16 v[80:95], a[108:111], a[140:143], v[80:95]
    ds_read_b128 a[132:135], v143 offset:61440
    s_bfe_u32 s48, s47, 0x20006
    s_mul_i32 s48, s48, 12288
    v_add_u32 v70, s48, v254
    v_add_u32 v71, s48, v255
    s_waitcnt lgkmcnt(4)
    v_mfma_f32_32x32x16_bf16 v[160:175], a[108:111], a[144:147], v[160:175]
    ds_read_b128 a[136:139], v143 offset:45056
    s_load_dwordx4 s[16:19], s[96:97], s74 offset:128
    buffer_load_dwordx4 a[32:35], v16, s[20:23], s8 offen offset:0 sc1
    v_mfma_f32_32x32x16_bf16 v[224:239], a[108:111], a[148:151], v[224:239]
    ds_read_b128 a[140:143], v143 offset:28672
    s_waitcnt lgkmcnt(4)
    v_mfma_f32_32x32x16_bf16 v[80:95], a[112:115], a[152:155], v[80:95]
    ds_read_b64_tr_b16 a[144:145], v67 offset:6144
    ds_read_b64_tr_b16 a[146:147], v67 offset:9216
    buffer_load_dwordx4 a[36:39], v16, s[20:23], s8 offen offset:1024 sc1
    v_mfma_f32_32x32x16_bf16 v[160:175], a[112:115], a[156:159], v[160:175]
    ds_read_b64_tr_b16 a[148:149], v66 offset:6144
    ds_read_b64_tr_b16 a[150:151], v66 offset:9216
    s_waitcnt lgkmcnt(6)
    v_mfma_f32_32x32x16_bf16 v[224:239], a[112:115], a[128:131], v[224:239]
    ds_read_b64_tr_b16 a[152:153], v67 offset:7168
    ds_read_b64_tr_b16 a[154:155], v67 offset:10240
    buffer_load_dwordx4 a[40:43], v17, s[20:23], s8 offen offset:0 sc1
    v_mfma_f32_32x32x16_bf16 v[80:95], a[116:119], a[132:135], v[80:95]
    ds_read_b64_tr_b16 a[156:157], v66 offset:7168
    ds_read_b64_tr_b16 a[158:159], v66 offset:10240
    s_waitcnt lgkmcnt(8)
    v_mfma_f32_32x32x16_bf16 v[160:175], a[116:119], a[136:139], v[160:175]
    ds_read_b64_tr_b16 a[128:129], v69 offset:6144
    ds_read_b64_tr_b16 a[130:131], v69 offset:9216
    buffer_load_dwordx4 a[44:47], v17, s[20:23], s8 offen offset:1024 sc1
    v_mfma_f32_32x32x16_bf16 v[224:239], a[116:119], a[140:143], v[224:239]
    ds_read_b64_tr_b16 a[132:133], v68 offset:6144
    ds_read_b64_tr_b16 a[134:135], v68 offset:9216
    s_waitcnt lgkmcnt(8)
    s_waitcnt vmcnt(12)
    v_mfma_f32_32x32x16_bf16 v[80:95], a[0:3], a[144:147], v[80:95]
    ds_read_b64_tr_b16 a[136:137], v69 offset:7168
    ds_read_b64_tr_b16 a[138:139], v69 offset:10240
    v_mfma_f32_32x32x16_bf16 v[160:175], a[0:3], a[148:151], v[160:175]
    ds_read_b64_tr_b16 a[140:141], v68 offset:7168
    ds_read_b64_tr_b16 a[142:143], v68 offset:10240
    s_waitcnt lgkmcnt(8)
    s_waitcnt vmcnt(11)
    v_mfma_f32_32x32x16_bf16 v[80:95], a[4:7], a[152:155], v[80:95]
    ds_read_b64_tr_b16 a[144:145], v71 offset:6144
    ds_read_b64_tr_b16 a[146:147], v71 offset:9216
    s_waitcnt lgkmcnt(0)
    s_xor_b64 s[16:17], s[16:17], s[78:79]
    s_xor_b64 s[18:19], s[18:19], s[78:79]
    s_or_b64 s[16:17], s[16:17], s[18:19]
    s_cbranch_scc1 L_slow_s2_r
L_ok_s2_r:
    buffer_load_dwordx4 a[48:51], v25, s[20:23], s9 offen offset:0 sc1
    v_mfma_f32_32x32x16_bf16 v[160:175], a[4:7], a[156:159], v[160:175]
    ds_read_b64_tr_b16 a[148:149], v70 offset:6144
    ds_read_b64_tr_b16 a[150:151], v70 offset:9216
    buffer_load_dwordx4 a[52:55], v25, s[20:23], s9 offen offset:1024 sc1
    s_waitcnt vmcnt(12)
    v_mfma_f32_32x32x16_bf16 v[80:95], a[8:11], a[128:131], v[80:95]
    ds_read_b64_tr_b16 a[152:153], v71 offset:7168
    ds_read_b64_tr_b16 a[154:155], v71 offset:10240
    v_mfma_f32_32x32x16_bf16 v[160:175], a[8:11], a[132:135], v[160:175]
    ds_read_b64_tr_b16 a[156:157], v70 offset:7168
    ds_read_b64_tr_b16 a[158:159], v70 offset:10240
    buffer_load_dwordx4 a[56:59], v25, s[20:23], s9 offen offset:2048 sc1
    s_waitcnt vmcnt(12)
    v_mfma_f32_32x32x16_bf16 v[80:95], a[12:15], a[136:139], v[80:95]
    ds_read_b64_tr_b16 a[128:129], v67 offset:8192
    ds_read_b64_tr_b16 a[130:131], v67 offset:11264
    v_mfma_f32_32x32x16_bf16 v[160:175], a[12:15], a[140:143], v[160:175]
    ds_read_b64_tr_b16 a[132:133], v66 offset:8192
    ds_read_b64_tr_b16 a[134:135], v66 offset:11264
    buffer_load_dwordx4 a[60:63], v25, s[20:23], s9 offen offset:3072 sc1
    s_waitcnt lgkmcnt(8)
    s_waitcnt vmcnt(12)
    v_mfma_f32_32x32x16_bf16 v[80:95], a[16:19], a[144:147], v[80:95]
    ds_read_b64_tr_b16 a[136:137], v253 offset:12288
    ds_read_b64_tr_b16 a[138:139], v253 offset:14336
    v_mfma_f32_32x32x16_bf16 v[160:175], a[16:19], a[148:151], v[160:175]
    ds_read_b64_tr_b16 a[140:141], v252 offset:12288
    ds_read_b64_tr_b16 a[142:143], v252 offset:14336
    buffer_load_dwordx4 a[64:67], v25, s[20:23], s10 offen offset:0 sc1
    s_waitcnt lgkmcnt(8)
    s_waitcnt vmcnt(12)
    v_mfma_f32_32x32x16_bf16 v[80:95], a[20:23], a[152:155], v[80:95]
    ds_read_b64_tr_b16 a[144:145], v69 offset:8192
    ds_read_b64_tr_b16 a[146:147], v69 offset:11264
    v_mfma_f32_32x32x16_bf16 v[160:175], a[20:23], a[156:159], v[160:175]
    ds_read_b64_tr_b16 a[148:149], v68 offset:8192
    ds_read_b64_tr_b16 a[150:151], v68 offset:11264
    buffer_load_dwordx4 a[68:71], v25, s[20:23], s10 offen offset:1024 sc1
    s_waitcnt lgkmcnt(8)
    s_waitcnt vmcnt(11)
    v_mfma_f32_32x32x16_bf16 v[80:95], a[24:27], a[128:131], v[80:95]
    ds_read_b64_tr_b16 a[152:153], v253 offset:20480
    ds_read_b64_tr_b16 a[154:155], v253 offset:22528
    v_mfma_f32_32x32x16_bf16 v[160:175], a[24:27], a[132:135], v[160:175]
    ds_read_b64_tr_b16 a[156:157], v252 offset:20480
    ds_read_b64_tr_b16 a[158:159], v252 offset:22528
    s_waitcnt lgkmcnt(8)
    s_waitcnt vmcnt(10)
    v_mfma_f32_32x32x16_bf16 v[80:95], a[28:31], a[136:139], v[80:95]
    ds_read_b64_tr_b16 a[128:129], v71 offset:8192
    ds_read_b64_tr_b16 a[130:131], v71 offset:11264
    s_waitcnt vmcnt(6)
    buffer_store_dword v8, v27, s[20:23], s67 offen offset:320 sc1
    v_mfma_f32_32x32x16_bf16 v[160:175], a[28:31], a[140:143], v[160:175]
    ds_read_b64_tr_b16 a[132:133], v70 offset:8192
    ds_read_b64_tr_b16 a[134:135], v70 offset:11264
    s_waitcnt lgkmcnt(8)
    v_mfma_f32_32x32x16_bf16 v[80:95], a[32:35], a[144:147], v[80:95]
    ds_read_b64_tr_b16 a[136:137], v253 offset:28672
    ds_read_b64_tr_b16 a[138:139], v253 offset:30720
    v_mfma_f32_32x32x16_bf16 v[160:175], a[32:35], a[148:151], v[160:175]
    ds_read_b64_tr_b16 a[140:141], v252 offset:28672
    ds_read_b64_tr_b16 a[142:143], v252 offset:30720
    s_waitcnt lgkmcnt(8)
    v_mfma_f32_32x32x16_bf16 v[80:95], a[36:39], a[152:155], v[80:95]
    ds_read_b64_tr_b16 a[144:145], v253 offset:5120
    ds_read_b64_tr_b16 a[146:147], v253 offset:7168
    s_load_dwordx4 s[28:31], s[96:97], s74 offset:192
    v_mfma_f32_32x32x16_bf16 v[160:175], a[36:39], a[156:159], v[160:175]
    ds_read_b64_tr_b16 a[148:149], v253 offset:13312
    ds_read_b64_tr_b16 a[150:151], v253 offset:15360
    s_waitcnt lgkmcnt(8)
    v_mfma_f32_32x32x16_bf16 v[80:95], a[40:43], a[128:131], v[80:95]
    ds_read_b64_tr_b16 a[152:153], v253 offset:21504
    ds_read_b64_tr_b16 a[154:155], v253 offset:23552
    v_mfma_f32_32x32x16_bf16 v[160:175], a[40:43], a[132:135], v[160:175]
    ds_read_b64_tr_b16 a[156:157], v253 offset:29696
    ds_read_b64_tr_b16 a[158:159], v253 offset:31744
    s_waitcnt lgkmcnt(8)
    v_mfma_f32_32x32x16_bf16 v[80:95], a[44:47], a[136:139], v[80:95]
    ds_read_b64_tr_b16 a[128:129], v253 offset:36864
    ds_read_b64_tr_b16 a[130:131], v253 offset:38912
    v_mfma_f32_32x32x16_bf16 v[160:175], a[44:47], a[140:143], v[160:175]
    ds_read_b64_tr_b16 a[132:133], v253 offset:37888
    ds_read_b64_tr_b16 a[134:135], v253 offset:39936
    s_waitcnt lgkmcnt(8)
    s_waitcnt vmcnt(6)
    v_mfma_f32_32x32x16_bf16 v[80:95], a[48:51], a[144:147], v[80:95]
    ds_read_b64_tr_b16 a[136:137], v252 offset:5120
    ds_read_b64_tr_b16 a[138:139], v252 offset:7168
    s_waitcnt vmcnt(5)
    v_mfma_f32_32x32x16_bf16 v[80:95], a[52:55], a[148:151], v[80:95]
    ds_read_b64_tr_b16 a[140:141], v252 offset:13312
    ds_read_b64_tr_b16 a[142:143], v252 offset:15360
    s_waitcnt lgkmcnt(8)
    s_waitcnt vmcnt(4)
    v_mfma_f32_32x32x16_bf16 v[80:95], a[56:59], a[152:155], v[80:95]
    ds_read_b64_tr_b16 a[144:145], v252 offset:21504
    ds_read_b64_tr_b16 a[146:147], v252 offset:23552
    s_waitcnt vmcnt(3)
    v_mfma_f32_32x32x16_bf16 v[80:95], a[60:63], a[156:159], v[80:95]
    ds_read_b64_tr_b16 a[148:149], v252 offset:29696
    ds_read_b64_tr_b16 a[150:151], v252 offset:31744
    s_waitcnt lgkmcnt(8)
    s_waitcnt vmcnt(2)
    v_mfma_f32_32x32x16_bf16 v[80:95], a[64:67], a[128:131], v[80:95]
    ds_read_b64_tr_b16 a[152:153], v252 offset:36864
    ds_read_b64_tr_b16 a[154:155], v252 offset:38912
    s_waitcnt lgkmcnt(0)
    s_xor_b64 s[28:29], s[28:29], s[78:79]
    s_xor_b64 s[30:31], s[30:31], s[78:79]
    s_or_b64 s[28:29], s[28:29], s[30:31]
    s_cbranch_scc1 L_slow_s4_r
L_ok_s4_r:
    s_waitcnt vmcnt(1)
    v_mfma_f32_32x32x16_bf16 v[80:95], a[68:71], a[132:135], v[80:95]
    ds_read_b64_tr_b16 a[156:157], v252 offset:37888
    ds_read_b64_tr_b16 a[158:159], v252 offset:39936
    v_mfma_f32_32x32x16_bf16 v[160:175], a[48:51], a[136:139], v[160:175]
    ds_read_b64_tr_b16 a[128:129], v67 offset:0
    ds_read_b64_tr_b16 a[130:131], v67 offset:3072
    s_nop 6
    s_nop 0
    v_cvt_pk_bf16_f32 v80, v80, v81
    v_cvt_pk_bf16_f32 v81, v82, v83
    v_cvt_pk_bf16_f32 v82, v84, v85
    v_cvt_pk_bf16_f32 v83, v86, v87
    v_mfma_f32_32x32x16_bf16 v[160:175], a[52:55], a[140:143], v[160:175]
    ds_read_b64_tr_b16 a[132:133], v67 offset:1024
    ds_read_b64_tr_b16 a[134:135], v67 offset:4096
    buffer_store_dwordx4 v[80:83], v25, s[20:23], s15 offen offset:0 sc1
    v_mfma_f32_32x32x16_bf16 v[160:175], a[56:59], a[144:147], v[160:175]
    ds_read_b64_tr_b16 a[136:137], v69 offset:0
    ds_read_b64_tr_b16 a[138:139], v69 offset:3072
    v_cvt_pk_bf16_f32 v84, v88, v89
    v_cvt_pk_bf16_f32 v85, v90, v91
    v_cvt_pk_bf16_f32 v86, v92, v93
    v_cvt_pk_bf16_f32 v87, v94, v95
    v_mfma_f32_32x32x16_bf16 v[160:175], a[60:63], a[148:151], v[160:175]
    ds_read_b64_tr_b16 a[140:141], v69 offset:1024
    ds_read_b64_tr_b16 a[142:143], v69 offset:4096
    buffer_store_dwordx4 v[84:87], v25, s[20:23], s15 offen offset:1024 sc1
    s_waitcnt lgkmcnt(8)
    s_nop 0
    v_mfma_f32_32x32x16_bf16 v[160:175], a[64:67], a[152:155], v[160:175]
    ds_read_b64_tr_b16 a[144:145], v71 offset:0
    ds_read_b64_tr_b16 a[146:147], v71 offset:3072
    v_add3_u32 v88, v80, v81, s52
    v_add3_u32 v88, v82, v83, v88
    v_add3_u32 v88, v84, v85, v88
    v_add3_u32 v88, v86, v87, v88
    v_mfma_f32_32x32x16_bf16 v[160:175], a[68:71], a[156:159], v[160:175]
    ds_read_b64_tr_b16 a[148:149], v71 offset:1024
    ds_read_b64_tr_b16 a[150:151], v71 offset:4096
    s_add_u32 s68, s15, s81
    buffer_store_dword v88, v13, s[20:23], s68 offen offset:0 sc1
    s_waitcnt lgkmcnt(8)
    v_mfma_f32_32x32x16_bf16 v[224:239], a[0:3], a[128:131], v[224:239]
    ds_read_b64_tr_b16 a[152:153], v67 offset:2048
    ds_read_b64_tr_b16 a[154:155], v67 offset:5120
    s_nop 3
    v_cvt_pk_bf16_f32 v160, v160, v161
    v_cvt_pk_bf16_f32 v161, v162, v163
    v_cvt_pk_bf16_f32 v162, v164, v165
    v_cvt_pk_bf16_f32 v163, v166, v167
    v_mfma_f32_32x32x16_bf16 v[224:239], a[4:7], a[132:135], v[224:239]
    ds_read_b64_tr_b16 a[156:157], v253 offset:8192
    ds_read_b64_tr_b16 a[158:159], v253 offset:10240
    buffer_store_dwordx4 v[160:163], v25, s[20:23], s41 offen offset:0 sc1
    s_waitcnt lgkmcnt(8)
    v_mfma_f32_32x32x16_bf16 v[224:239], a[8:11], a[136:139], v[224:239]
    ds_read_b64_tr_b16 a[128:129], v69 offset:2048
    ds_read_b64_tr_b16 a[130:131], v69 offset:5120
    v_cvt_pk_bf16_f32 v164, v168, v169
    v_cvt_pk_bf16_f32 v165, v170, v171
    v_cvt_pk_bf16_f32 v166, v172, v173
    v_cvt_pk_bf16_f32 v167, v174, v175
    v_mfma_f32_32x32x16_bf16 v[224:239], a[12:15], a[140:143], v[224:239]
    ds_read_b64_tr_b16 a[132:133], v253 offset:16384
    ds_read_b64_tr_b16 a[134:135], v253 offset:18432
    buffer_store_dwordx4 v[164:167], v25, s[20:23], s41 offen offset:1024 sc1
    s_waitcnt lgkmcnt(8)
    s_nop 0
    v_mfma_f32_32x32x16_bf16 v[224:239], a[16:19], a[144:147], v[224:239]
    ds_read_b64_tr_b16 a[136:137], v71 offset:2048
    ds_read_b64_tr_b16 a[138:139], v71 offset:5120
    s_load_dwordx4 s[24:27], s[96:97], s74 offset:320
    v_add3_u32 v168, v160, v161, s52
    v_add3_u32 v168, v162, v163, v168
    v_add3_u32 v168, v164, v165, v168
    v_add3_u32 v168, v166, v167, v168
    v_mfma_f32_32x32x16_bf16 v[224:239], a[20:23], a[148:151], v[224:239]
    ds_read_b64_tr_b16 a[140:141], v253 offset:24576
    ds_read_b64_tr_b16 a[142:143], v253 offset:26624
    s_add_u32 s68, s41, s80
    buffer_store_dword v168, v13, s[20:23], s68 offen offset:256 sc1
    s_waitcnt lgkmcnt(8)
    v_mfma_f32_32x32x16_bf16 v[224:239], a[24:27], a[152:155], v[224:239]
    ds_read_b64_tr_b16 a[144:145], v253 offset:1024
    ds_read_b64_tr_b16 a[146:147], v253 offset:3072
    v_mfma_f32_32x32x16_bf16 v[224:239], a[28:31], a[156:159], v[224:239]
    ds_read_b64_tr_b16 a[148:149], v253 offset:9216
    ds_read_b64_tr_b16 a[150:151], v253 offset:11264
    s_waitcnt lgkmcnt(8)
    v_mfma_f32_32x32x16_bf16 v[224:239], a[32:35], a[128:131], v[224:239]
    ds_read_b64_tr_b16 a[152:153], v253 offset:17408
    ds_read_b64_tr_b16 a[154:155], v253 offset:19456
    v_mfma_f32_32x32x16_bf16 v[224:239], a[36:39], a[132:135], v[224:239]
    ds_read_b64_tr_b16 a[156:157], v253 offset:25600
    ds_read_b64_tr_b16 a[158:159], v253 offset:27648
    s_waitcnt lgkmcnt(8)
    v_mfma_f32_32x32x16_bf16 v[224:239], a[40:43], a[136:139], v[224:239]
    ds_read_b64_tr_b16 a[128:129], v253 offset:32768
    ds_read_b64_tr_b16 a[130:131], v253 offset:34816
    v_mfma_f32_32x32x16_bf16 v[224:239], a[44:47], a[140:143], v[224:239]
    ds_read_b64_tr_b16 a[132:133], v253 offset:33792
    ds_read_b64_tr_b16 a[134:135], v253 offset:35840
    s_waitcnt lgkmcnt(8)
    v_mfma_f32_32x32x16_bf16 v[224:239], a[48:51], a[144:147], v[224:239]
    ds_read_b128 a[136:139], v140 offset:0
    v_mfma_f32_32x32x16_bf16 v[224:239], a[52:55], a[148:151], v[224:239]
    ds_read_b128 a[140:143], v141 offset:0
    s_waitcnt lgkmcnt(6)
    v_mfma_f32_32x32x16_bf16 v[224:239], a[56:59], a[152:155], v[224:239]
    ds_read_b128 a[144:147], v140 offset:8192
    v_mfma_f32_32x32x16_bf16 v[224:239], a[60:63], a[156:159], v[224:239]
    ds_read_b128 a[148:151], v141 offset:8192
    s_waitcnt lgkmcnt(4)
    v_mfma_f32_32x32x16_bf16 v[224:239], a[64:67], a[128:131], v[224:239]
    ds_read_b128 a[152:155], v142 offset:0
    s_waitcnt lgkmcnt(0)
    s_xor_b64 s[24:25], s[24:25], s[78:79]
    s_xor_b64 s[26:27], s[26:27], s[78:79]
    s_or_b64 s[24:25], s[24:25], s[26:27]
    s_cbranch_scc1 L_slow_s7_r
L_ok_s7_r:
    v_mfma_f32_32x32x16_bf16 v[224:239], a[68:71], a[132:135], v[224:239]
    ds_read_b128 a[156:159], v143 offset:0
    v_mfma_f32_32x32x16_bf16 v[96:111], a[160:163], a[136:139], v[96:111]
    ds_read_b128 a[128:131], v142 offset:8192
    s_nop 8
    s_nop 0
    v_cvt_pk_bf16_f32 v224, v224, v225
    v_cvt_pk_bf16_f32 v225, v226, v227
    v_cvt_pk_bf16_f32 v226, v228, v229
    v_cvt_pk_bf16_f32 v227, v230, v231
    buffer_store_dwordx4 v[224:227], v25, s[20:23], s64 offen offset:0 sc1
    v_mfma_f32_32x32x16_bf16 v[96:111], a[164:167], a[140:143], v[96:111]
    ds_read_b128 a[132:135], v143 offset:8192
    v_cvt_pk_bf16_f32 v228, v232, v233
    v_cvt_pk_bf16_f32 v229, v234, v235
    v_cvt_pk_bf16_f32 v230, v236, v237
    v_cvt_pk_bf16_f32 v231, v238, v239
    v_mfma_f32_32x32x16_bf16 v[96:111], a[168:171], a[144:147], v[96:111]
    ds_read_b128 a[136:139], v140 offset:4096
    buffer_store_dwordx4 v[228:231], v25, s[20:23], s64 offen offset:1024 sc1
    v_add3_u32 v232, v224, v225, s52
    v_add3_u32 v232, v226, v227, v232
    v_add3_u32 v232, v228, v229, v232
    v_add3_u32 v232, v230, v231, v232
    v_mfma_f32_32x32x16_bf16 v[96:111], a[172:175], a[148:151], v[96:111]
    ds_read_b128 a[140:143], v141 offset:4096
    s_add_u32 s68, s64, 8192
    buffer_store_dword v232, v13, s[20:23], s68 offen offset:0 sc1
    s_waitcnt lgkmcnt(4)
    v_mfma_f32_32x32x16_bf16 v[96:111], a[72:75], a[152:155], v[96:111]
    ds_read_b128 a[144:147], v140 offset:12288
    v_mfma_f32_32x32x16_bf16 v[96:111], a[76:79], a[156:159], v[96:111]
    ds_read_b128 a[148:151], v141 offset:12288
    s_waitcnt lgkmcnt(4)
    v_mfma_f32_32x32x16_bf16 v[96:111], a[80:83], a[128:131], v[96:111]
    ds_read_b128 a[152:155], v142 offset:4096
    v_mfma_f32_32x32x16_bf16 v[96:111], a[84:87], a[132:135], v[96:111]
    ds_read_b128 a[156:159], v143 offset:4096
    s_waitcnt lgkmcnt(4)
    v_mfma_f32_32x32x16_bf16 v[96:111], a[88:91], a[136:139], v[96:111]
    ds_read_b128 a[128:131], v142 offset:12288
    s_xor_b32 s76, s43, 3
    s_sub_i32 s76, s76, s43
    s_mul_i32 s76, s76, 40960
    s_add_u32 s76, s76, s15
    buffer_load_dwordx4 v[80:83], v25, s[20:23], s76 offen sc1
    v_mfma_f32_32x32x16_bf16 v[96:111], a[92:95], a[140:143], v[96:111]
    ds_read_b128 a[132:135], v143 offset:12288
    buffer_load_dwordx4 v[84:87], v25, s[20:23], s76 offen offset:1024 sc1
    s_add_u32 s76, s76, s81
    buffer_load_dword v88, v13, s[20:23], s76 offen offset:0 sc1
    s_waitcnt lgkmcnt(4)
    v_mfma_f32_32x32x16_bf16 v[96:111], a[96:99], a[144:147], v[96:111]
    ds_read_b64_tr_b16 a[136:137], v64 offset:0
    ds_read_b64_tr_b16 a[138:139], v64 offset:3072
    v_mfma_f32_32x32x16_bf16 v[96:111], a[100:103], a[148:151], v[96:111]
    ds_read_b64_tr_b16 a[140:141], v64 offset:1024
    ds_read_b64_tr_b16 a[142:143], v64 offset:4096
    s_waitcnt lgkmcnt(6)
    v_mfma_f32_32x32x16_bf16 v[96:111], a[104:107], a[152:155], v[96:111]
    ds_read_b64_tr_b16 a[144:145], v64 offset:2048
    ds_read_b64_tr_b16 a[146:147], v64 offset:5120
    s_xor_b32 s76, s43, 2
    s_sub_i32 s76, s76, s43
    s_mul_i32 s76, s76, 40960
    s_add_u32 s76, s76, s41
    buffer_load_dwordx4 v[160:163], v25, s[20:23], s76 offen sc1
    v_mfma_f32_32x32x16_bf16 v[96:111], a[108:111], a[156:159], v[96:111]
    ds_read_b64_tr_b16 a[148:149], v252 offset:0
    ds_read_b64_tr_b16 a[150:151], v252 offset:2048
    buffer_load_dwordx4 v[164:167], v25, s[20:23], s76 offen offset:1024 sc1
    s_waitcnt lgkmcnt(8)
    v_mfma_f32_32x32x16_bf16 v[96:111], a[112:115], a[128:131], v[96:111]
    ds_read_b64_tr_b16 a[152:153], v66 offset:0
    ds_read_b64_tr_b16 a[154:155], v66 offset:3072
    s_add_u32 s76, s76, s80
    buffer_load_dword v168, v13, s[20:23], s76 offen offset:256 sc1
    v_mfma_f32_32x32x16_bf16 v[96:111], a[116:119], a[132:135], v[96:111]
    ds_read_b64_tr_b16 a[156:157], v66 offset:1024
    ds_read_b64_tr_b16 a[158:159], v66 offset:4096
    s_waitcnt lgkmcnt(8)
    v_mfma_f32_32x32x16_bf16 v[96:111], v[176:179], a[136:139], v[96:111]
    ds_read_b64_tr_b16 a[128:129], v68 offset:0
    ds_read_b64_tr_b16 a[130:131], v68 offset:3072
    v_mfma_f32_32x32x16_bf16 v[96:111], v[180:183], a[140:143], v[96:111]
    ds_read_b64_tr_b16 a[132:133], v68 offset:1024
    ds_read_b64_tr_b16 a[134:135], v68 offset:4096
    s_waitcnt lgkmcnt(8)
    v_mfma_f32_32x32x16_bf16 v[96:111], v[192:195], a[144:147], v[96:111]
    ds_read_b64_tr_b16 a[136:137], v70 offset:0
    ds_read_b64_tr_b16 a[138:139], v70 offset:3072
    s_xor_b32 s76, s43, 1
    s_sub_i32 s76, s76, s43
    s_mul_i32 s76, s76, 40960
    s_add_u32 s76, s76, s64
    buffer_load_dwordx4 v[224:227], v25, s[20:23], s76 offen sc1
    v_mfma_f32_32x32x16_bf16 v[96:111], v[196:199], a[148:151], v[96:111]
    ds_read_b64_tr_b16 a[140:141], v70 offset:1024
    ds_read_b64_tr_b16 a[142:143], v70 offset:4096
    buffer_load_dwordx4 v[228:231], v25, s[20:23], s76 offen offset:1024 sc1
    s_waitcnt lgkmcnt(8)
    v_mfma_f32_32x32x16_bf16 v[96:111], a[0:3], a[152:155], v[96:111]
    ds_read_b64_tr_b16 a[144:145], v66 offset:2048
    ds_read_b64_tr_b16 a[146:147], v66 offset:5120
    s_add_u32 s76, s76, 8192
    buffer_load_dword v232, v13, s[20:23], s76 offen offset:0 sc1
    v_mfma_f32_32x32x16_bf16 v[96:111], a[4:7], a[156:159], v[96:111]
    ds_read_b64_tr_b16 a[148:149], v252 offset:8192
    ds_read_b64_tr_b16 a[150:151], v252 offset:10240
    s_waitcnt lgkmcnt(8)
    v_mfma_f32_32x32x16_bf16 v[96:111], a[8:11], a[128:131], v[96:111]
    ds_read_b64_tr_b16 a[152:153], v68 offset:2048
    ds_read_b64_tr_b16 a[154:155], v68 offset:5120
    v_mfma_f32_32x32x16_bf16 v[96:111], a[12:15], a[132:135], v[96:111]
    ds_read_b64_tr_b16 a[156:157], v252 offset:16384
    ds_read_b64_tr_b16 a[158:159], v252 offset:18432
    s_waitcnt lgkmcnt(8)
    v_mfma_f32_32x32x16_bf16 v[96:111], a[16:19], a[136:139], v[96:111]
    ds_read_b64_tr_b16 a[128:129], v70 offset:2048
    ds_read_b64_tr_b16 a[130:131], v70 offset:5120
    v_mfma_f32_32x32x16_bf16 v[96:111], a[20:23], a[140:143], v[96:111]
    ds_read_b64_tr_b16 a[132:133], v252 offset:24576
    ds_read_b64_tr_b16 a[134:135], v252 offset:26624
    s_waitcnt lgkmcnt(8)
    v_mfma_f32_32x32x16_bf16 v[96:111], a[24:27], a[144:147], v[96:111]
    ds_read_b64_tr_b16 a[136:137], v252 offset:1024
    ds_read_b64_tr_b16 a[138:139], v252 offset:3072
    v_mfma_f32_32x32x16_bf16 v[96:111], a[28:31], a[148:151], v[96:111]
    ds_read_b64_tr_b16 a[140:141], v252 offset:9216
    ds_read_b64_tr_b16 a[142:143], v252 offset:11264
    s_waitcnt lgkmcnt(8)
    v_mfma_f32_32x32x16_bf16 v[96:111], a[32:35], a[152:155], v[96:111]
    ds_read_b64_tr_b16 a[144:145], v252 offset:17408
    ds_read_b64_tr_b16 a[146:147], v252 offset:19456
    v_mfma_f32_32x32x16_bf16 v[96:111], a[36:39], a[156:159], v[96:111]
    ds_read_b64_tr_b16 a[148:149], v252 offset:25600
    ds_read_b64_tr_b16 a[150:151], v252 offset:27648
    s_waitcnt lgkmcnt(8)
    v_mfma_f32_32x32x16_bf16 v[96:111], a[40:43], a[128:131], v[96:111]
    ds_read_b64_tr_b16 a[152:153], v252 offset:32768
    ds_read_b64_tr_b16 a[154:155], v252 offset:34816
    v_mfma_f32_32x32x16_bf16 v[96:111], a[44:47], a[132:135], v[96:111]
    ds_read_b64_tr_b16 a[156:157], v252 offset:33792
    ds_read_b64_tr_b16 a[158:159], v252 offset:35840
    s_waitcnt lgkmcnt(8)
    v_mfma_f32_32x32x16_bf16 v[96:111], a[48:51], a[136:139], v[96:111]
    v_mfma_f32_32x32x16_bf16 v[96:111], a[52:55], a[140:143], v[96:111]
    s_waitcnt lgkmcnt(4)
    v_mfma_f32_32x32x16_bf16 v[96:111], a[56:59], a[144:147], v[96:111]
    v_mfma_f32_32x32x16_bf16 v[96:111], a[60:63], a[148:151], v[96:111]
    s_waitcnt lgkmcnt(0)
    v_mfma_f32_32x32x16_bf16 v[96:111], a[64:67], a[152:155], v[96:111]
    v_mfma_f32_32x32x16_bf16 v[96:111], a[68:71], a[156:159], v[96:111]
    s_waitcnt vmcnt(8)
    v_add3_u32 v89, v80, v81, s52
    v_add3_u32 v89, v82, v83, v89
    s_waitcnt vmcnt(7)
    v_add3_u32 v89, v84, v85, v89
    v_add3_u32 v89, v86, v87, v89
    s_waitcnt vmcnt(6)
    v_xor_b32 v89, v89, v88
    s_waitcnt vmcnt(5)
    v_add3_u32 v169, v160, v161, s52
    v_add3_u32 v169, v162, v163, v169
    s_waitcnt vmcnt(4)
    v_add3_u32 v169, v164, v165, v169
    v_add3_u32 v169, v166, v167, v169
    s_waitcnt vmcnt(3)
    v_xor_b32 v169, v169, v168
    s_waitcnt vmcnt(2)
    v_add3_u32 v233, v224, v225, s52
    v_add3_u32 v233, v226, v227, v233
    s_waitcnt vmcnt(1)
    v_add3_u32 v233, v228, v229, v233
    v_add3_u32 v233, v230, v231, v233
    s_waitcnt vmcnt(0)
    v_xor_b32 v233, v233, v232
    v_or3_b32 v89, v89, v169, v233
    v_cmp_ne_u32_e64 s[88:89], 0, v89
    s_nop 1
    s_cmp_lg_u64 s[88:89], 0
    s_cbranch_scc1 L_slow_q321_r
L_ok_q321_r:
    s_add_u32 s50, s1, 0
    v_dot2_f32_bf16 v96, v80, s56, v96
    v_dot2_f32_bf16 v97, v80, s57, v97
    v_dot2_f32_bf16 v96, v160, s56, v96
    v_dot2_f32_bf16 v97, v160, s57, v97
    v_dot2_f32_bf16 v96, v224, s56, v96
    v_dot2_f32_bf16 v97, v224, s57, v97
    s_mov_b32 s49, s50
    s_nop 0
    buffer_store_dword v96, v14, s[36:39], s50 offen sc1
    s_add_u32 s50, s1, 4096
    v_dot2_f32_bf16 v98, v81, s56, v98
    v_dot2_f32_bf16 v99, v81, s57, v99
    v_dot2_f32_bf16 v98, v161, s56, v98
    v_dot2_f32_bf16 v99, v161, s57, v99
    v_dot2_f32_bf16 v98, v225, s56, v98
    v_dot2_f32_bf16 v99, v225, s57, v99
    buffer_store_dword v97, v14, s[36:39], s49 offen offset:2048 sc1
    s_mov_b32 s49, s50
    buffer_store_dword v98, v14, s[36:39], s50 offen sc1
    s_add_u32 s50, s1, 8192
    v_dot2_f32_bf16 v100, v82, s56, v100
    v_dot2_f32_bf16 v101, v82, s57, v101
    v_dot2_f32_bf16 v100, v162, s56, v100
    v_dot2_f32_bf16 v101, v162, s57, v101
    v_dot2_f32_bf16 v100, v226, s56, v100
    v_dot2_f32_bf16 v101, v226, s57, v101
    buffer_store_dword v99, v14, s[36:39], s49 offen offset:2048 sc1
    s_mov_b32 s49, s50
    buffer_store_dword v100, v14, s[36:39], s50 offen sc1
    s_add_u32 s50, s1, 12288
    v_dot2_f32_bf16 v102, v83, s56, v102
    v_dot2_f32_bf16 v103, v83, s57, v103
    v_dot2_f32_bf16 v102, v163, s56, v102
    v_dot2_f32_bf16 v103, v163, s57, v103
    v_dot2_f32_bf16 v102, v227, s56, v102
    v_dot2_f32_bf16 v103, v227, s57, v103
    buffer_store_dword v101, v14, s[36:39], s49 offen offset:2048 sc1
    s_mov_b32 s49, s50
    buffer_store_dword v102, v14, s[36:39], s50 offen sc1
    s_add_u32 s50, s1, 16384
    v_dot2_f32_bf16 v104, v84, s56, v104
    v_dot2_f32_bf16 v105, v84, s57, v105
    v_dot2_f32_bf16 v104, v164, s56, v104
    v_dot2_f32_bf16 v105, v164, s57, v105
    v_dot2_f32_bf16 v104, v228, s56, v104
    v_dot2_f32_bf16 v105, v228, s57, v105
    buffer_store_dword v103, v14, s[36:39], s49 offen offset:2048 sc1
    s_mov_b32 s49, s50
    buffer_store_dword v104, v14, s[36:39], s50 offen sc1
    s_add_u32 s50, s1, 20480
    v_dot2_f32_bf16 v106, v85, s56, v106
    v_dot2_f32_bf16 v107, v85, s57, v107
    v_dot2_f32_bf16 v106, v165, s56, v106
    v_dot2_f32_bf16 v107, v165, s57, v107
    v_dot2_f32_bf16 v106, v229, s56, v106
    v_dot2_f32_bf16 v107, v229, s57, v107
    buffer_store_dword v105, v14, s[36:39], s49 offen offset:2048 sc1
    s_mov_b32 s49, s50
    buffer_store_dword v106, v14, s[36:39], s50 offen sc1
    s_add_u32 s50, s1, 24576
    v_dot2_f32_bf16 v108, v86, s56, v108
    v_dot2_f32_bf16 v109, v86, s57, v109
    v_dot2_f32_bf16 v108, v166, s56, v108
    v_dot2_f32_bf16 v109, v166, s57, v109
    v_dot2_f32_bf16 v108, v230, s56, v108
    v_dot2_f32_bf16 v109, v230, s57, v109
    buffer_store_dword v107, v14, s[36:39], s49 offen offset:2048 sc1
    s_mov_b32 s49, s50
    buffer_store_dword v108, v14, s[36:39], s50 offen sc1
    s_add_u32 s50, s1, 28672
    v_dot2_f32_bf16 v110, v87, s56, v110
    v_dot2_f32_bf16 v111, v87, s57, v111
    v_dot2_f32_bf16 v110, v167, s56, v110
    v_dot2_f32_bf16 v111, v167, s57, v111
    v_dot2_f32_bf16 v110, v231, s56, v110
    v_dot2_f32_bf16 v111, v231, s57, v111
    buffer_store_dword v109, v14, s[36:39], s49 offen offset:2048 sc1
    s_mov_b32 s49, s50
    buffer_store_dword v110, v14, s[36:39], s50 offen sc1
    buffer_store_dword v111, v14, s[36:39], s50 offen offset:2048 sc1
    v_mov_b32 v9, s53
    s_mov_b32 s48, 2146435072
    s_cmp_eq_u32 s83, 960
    s_cselect_b32 s47, 11010048, s48
    buffer_store_dwordx2 v[8:9], v27, s[20:23], s47 offen sc1
    s_endpgm
L_slow_s3_r:
    s_mov_b32 s82, 0
L_slow_s3b_r:
    buffer_load_dword v23, v24, s[20:23], s74 offen offset:0 sc1
    s_add_u32 s82, s82, 1
    s_cmp_ge_u32 s82, 20000
    s_waitcnt vmcnt(0)
    s_cbranch_scc1 L_ok_s3_r
    v_cmp_ne_u32_e64 s[88:89], v23, s52
    s_nop 1
    s_and_b32 s88, s88, 0xf0000
    s_cbranch_scc1 L_slow_s3b_r
    s_branch L_ok_s3_r
L_slow_s5_r:
    s_mov_b32 s82, 0
L_slow_s5b_r:
    buffer_load_dword v23, v24, s[20:23], s74 offen offset:0 sc1
    s_add_u32 s82, s82, 1
    s_cmp_ge_u32 s82, 20000
    s_waitcnt vmcnt(0)
    s_cbranch_scc1 L_ok_s5_r
    v_cmp_ne_u32_e64 s[88:89], v23, s52
    s_nop 1
    s_and_b32 s88, s88, 0xff
    s_cbranch_scc1 L_slow_s5b_r
    s_branch L_ok_s5_r
L_slow_s2_r:
    s_mov_b32 s82, 0
L_slow_s2b_r:
    buffer_load_dword v23, v24, s[20:23], s74 offen offset:0 sc1
    s_add_u32 s82, s82, 1
    s_cmp_ge_u32 s82, 20000
    s_waitcnt vmcnt(0)
    s_cbranch_scc1 L_ok_s2_r
    v_cmp_ne_u32_e64 s[88:89], v23, s52
    s_nop 1
    s_and_b32 s88, s88, 0xf00
    s_cbranch_scc1 L_slow_s2b_r
    s_branch L_ok_s2_r
L_slow_s4_r:
    s_mov_b32 s82, 0
L_slow_s4b_r:
    buffer_load_dword v23, v24, s[20:23], s74 offen offset:0 sc1
    s_add_u32 s82, s82, 1
    s_cmp_ge_u32 s82, 20000
    s_waitcnt vmcnt(0)
    s_cbranch_scc1 L_ok_s4_r
    v_cmp_ne_u32_e64 s[88:89], v23, s52
    s_nop 1
    s_and_b32 s88, s88, 0xf000
    s_cbranch_scc1 L_slow_s4b_r
    s_branch L_ok_s4_r
L_slow_s7_r:
    s_mov_b32 s82, 0
L_slow_s7b_r:
    buffer_load_dword v23, v24, s[20:23], s74 offen offset:0 sc1
    s_add_u32 s82, s82, 1
    s_cmp_ge_u32 s82, 20000
    s_waitcnt vmcnt(0)
    s_cbranch_scc1 L_ok_s7_r
    v_cmp_ne_u32_e64 s[88:89], v23, s52
    s_nop 1
    s_and_b32 s88, s88, 0xf00000
    s_cbranch_scc1 L_slow_s7b_r
    s_branch L_ok_s7_r
L_slow_q321_r:
    s_mov_b32 s82, 0
L_slow_qb321_r:
    s_xor_b32 s76, s43, 3
    s_sub_i32 s76, s76, s43
    s_mul_i32 s76, s76, 40960
    s_add_u32 s76, s76, s15
    buffer_load_dwordx4 v[80:83], v25, s[20:23], s76 offen sc1
    buffer_load_dwordx4 v[84:87], v25, s[20:23], s76 offen offset:1024 sc1
    s_add_u32 s76, s76, s81
    buffer_load_dword v88, v13, s[20:23], s76 offen offset:0 sc1
    s_xor_b32 s76, s43, 2
    s_sub_i32 s76, s76, s43
    s_mul_i32 s76, s76, 40960
    s_add_u32 s76, s76, s41
    buffer_load_dwordx4 v[160:163], v25, s[20:23], s76 offen sc1
    buffer_load_dwordx4 v[164:167], v25, s[20:23], s76 offen offset:1024 sc1
    s_add_u32 s76, s76, s80
    buffer_load_dword v168, v13, s[20:23], s76 offen offset:256 sc1
    s_xor_b32 s76, s43, 1
    s_sub_i32 s76, s76, s43
    s_mul_i32 s76, s76, 40960
    s_add_u32 s76, s76, s64
    buffer_load_dwordx4 v[224:227], v25, s[20:23], s76 offen sc1
    buffer_load_dwordx4 v[228:231], v25, s[20:23], s76 offen offset:1024 sc1
    s_add_u32 s76, s76, 8192
    buffer_load_dword v232, v13, s[20:23], s76 offen offset:0 sc1
    s_add_u32 s82, s82, 1
    s_waitcnt vmcnt(0)
    v_add3_u32 v89, v80, v81, s52
    v_add3_u32 v89, v82, v83, v89
    v_add3_u32 v89, v84, v85, v89
    v_add3_u32 v89, v86, v87, v89
    v_xor_b32 v89, v89, v88
    v_add3_u32 v169, v160, v161, s52
    v_add3_u32 v169, v162, v163, v169
    v_add3_u32 v169, v164, v165, v169
    v_add3_u32 v169, v166, v167, v169
    v_xor_b32 v169, v169, v168
    v_add3_u32 v233, v224, v225, s52
    v_add3_u32 v233, v226, v227, v233
    v_add3_u32 v233, v228, v229, v233
    v_add3_u32 v233, v230, v231, v233
    v_xor_b32 v233, v233, v232
    v_or3_b32 v89, v89, v169, v233
    v_cmp_ne_u32_e64 s[88:89], 0, v89
    s_cmp_ge_u32 s82, 20000
    s_cbranch_scc1 L_ok_q321_r
    s_nop 1
    s_cmp_lg_u64 s[88:89], 0
    s_cbranch_scc1 L_slow_qb321_r
    s_branch L_ok_q321_r
L_end:
    s_endpgm
.section .rodata,"a"
.p2align 6
.amdhsa_kernel parallel_sum__ssm_conv_s5__mixer_channel_mlp__prompt_kernel
  .amdhsa_next_free_vgpr 512
  .amdhsa_next_free_sgpr 102
  .amdhsa_accum_offset 256
  .amdhsa_group_segment_fixed_size 0
  .amdhsa_kernarg_size 136
  .amdhsa_user_sgpr_count 2
  .amdhsa_user_sgpr_kernarg_segment_ptr 1
  .amdhsa_system_sgpr_workgroup_id_x 1
.end_amdhsa_kernel
```
